```python
import torch

def _softmax(x, axis=-1):
    return torch.softmax(x, dim=axis)
def _gelu(x):
    return torch.nn.functional.gelu(x, approximate="tanh")
def _silu(x):
    return torch.nn.functional.silu(x)
def _sigmoid(x):
    return torch.sigmoid(x)
def _layernorm(x, axis=-1, eps=1e-5):
    m = x.mean(dim=axis, keepdim=True)
    v = x.var(dim=axis, keepdim=True, unbiased=False)
    return (x - m) / torch.sqrt(v + eps)
def _scatter_add(tgt, idx, src, axis=0):
    return tgt.clone().index_add_(axis, idx, src)
def _segment_sum(src, seg, n):
    out = torch.zeros((n,) + src.shape[1:], dtype=src.dtype)
    return out.index_add_(0, seg, src)
def _pad(x, pw):
    flat = tuple(v for pair in reversed(pw) for v in pair)
    return torch.nn.functional.pad(x, flat)

kernel_name = 'recurrent_scan__gqa_block_cached__glu_gated_bilinear__prompt'

def setup_inputs():

    _w = (lambda a: (lambda t: t.to(torch.bfloat16) if t.is_floating_point() else t)(torch.as_tensor(a)))
    def _A_setup():
        B, Sq, D = 1, 2048, 512
        Hq, Hkv, Sk, Dh = 32, 32, 2048, 128
        assert Hq % Hkv == 0, (Hq, Hkv)
        return {
            "x": _w((lambda *s: torch.randn(*s, dtype=torch.bfloat16) * 0.05)(B, Sq, D)),
            "k_cache": _w((lambda *s: torch.randn(*s, dtype=torch.bfloat16) * 1.6)(B, Hkv, Sk, Dh)),
            "v_cache": _w((lambda *s: torch.randn(*s, dtype=torch.bfloat16) * 1.6)(B, Hkv, Sk, Dh)),
            "wq": _w((lambda *s: torch.randn(*s, dtype=torch.bfloat16) * 1.6)(D, Hq * Dh) * (D ** -0.5)),
            "wo": _w((lambda *s: torch.randn(*s, dtype=torch.bfloat16) * 1.6)(Hq * Dh, D) * ((Hq * Dh) ** -0.5)),
        }
    _A_in = _A_setup()

    def _B_setup():
        B, S, D, F = 1, 2048, 512, 1376
        return {
            "x": _w((lambda *s: torch.randn(*s, dtype=torch.bfloat16) * 0.05)(B, S, D)),
            "w_gate": _w((lambda *s: torch.randn(*s, dtype=torch.bfloat16) * 0.2)(D, F) * (D ** -0.5)),
            "w_up": _w((lambda *s: torch.randn(*s, dtype=torch.bfloat16) * 0.2)(D, F) * (D ** -0.5)),
            "w_down": _w((lambda *s: torch.randn(*s, dtype=torch.bfloat16) * 0.2)(F, D) * (F ** -0.5)),
        }
    _B_in = _B_setup()

    return {
        "A_x": _A_in["x"],
        "A_k_cache": _A_in["k_cache"],
        "A_v_cache": _A_in["v_cache"],
        "A_wq": _A_in["wq"],
        "A_wo": _A_in["wo"],
        "B_x": _B_in["x"],
        "B_w_gate": _B_in["w_gate"],
        "B_w_up": _B_in["w_up"],
        "B_w_down": _B_in["w_down"],
    }

def reference(A_x, A_k_cache, A_v_cache, A_wq, A_wo, B_x, B_w_gate, B_w_up, B_w_down):
    def _A_ref(x, k_cache, v_cache, wq, wo):
        B, Sq, D = x.shape
        Hq, Dh = 32, 128
        Hkv = k_cache.shape[1]
        rep = Hq // Hkv
        q = (lambda x, *d: x.permute(*d))((x @ wq).reshape(B, Sq, Hq, Dh), 0, 2, 1, 3)
        k = (lambda x, n, axis: torch.repeat_interleave(x, n, dim=axis))(k_cache, rep, axis=1)
        v = (lambda x, n, axis: torch.repeat_interleave(x, n, dim=axis))(v_cache, rep, axis=1)
        scores = torch.einsum("bhqd,bhkd->bhqk", q, k) * (Dh ** -0.5)
        p = _softmax(scores, axis=-1)
        o = torch.einsum("bhqk,bhkd->bhqd", p, v)
        return (lambda x, *d: x.permute(*d))(o, 0, 2, 1, 3).reshape(B, Sq, Hq * Dh) @ wo

    def _B_ref(x, w_gate, w_up, w_down):
        g = torch.einsum("bsd,df->bsf", x, w_gate)
        u = torch.einsum("bsd,df->bsf", x, w_up)
        h = g * u
        return torch.einsum("bsf,fd->bsd", h, w_down)

    x = A_x
    xn = _layernorm(x, axis=-1)
    s = _A_ref(xn, A_k_cache, A_v_cache, A_wq, A_wo)
    g = _silu(_B_ref(xn, B_w_gate, B_w_up, B_w_down))
    return x + s * g
```

```asm
; @launch kernel=ka_kernel grid=(256,1,1) block=(256,1,1) lds=163840
.amdgcn_target "amdgcn-amd-amdhsa--gfx950"
.text
.globl ka_kernel
.p2align 8
.type ka_kernel,@function
ka_kernel:
  s_cmp_ge_u32 s2, 256
  s_cbranch_scc1 KA_END
  s_load_dwordx8 s[4:11], s[0:1], 0
  s_load_dwordx4 s[12:15], s[0:1], 48
  s_load_dwordx2 s[16:17], s[0:1], 88
  s_load_dwordx2 s[18:19], s[0:1], 32
  s_load_dwordx2 s[66:67], s[0:1], 64
  s_load_dwordx4 s[72:75], s[0:1], 72
  v_lshrrev_b32 v1, 6, v0
  v_and_b32 v240, 63, v0
  v_readfirstlane_b32 s48, v1
  s_and_b32 s51, s2, 7
  s_lshl_b32 s51, s51, 2
  s_bfe_u32 s52, s2, 0x20003
  s_add_u32 s49, s51, s52
  s_lshr_b32 s50, s2, 5
  v_lshrrev_b32 v204, 4, v240
  v_bfe_u32 v205, v240, 2, 2
  v_and_b32 v206, 3, v240
  v_and_b32 v207, 15, v240
  v_lshlrev_b32 v241, 4, v240
  s_lshl_b32 s53, s50, 8
  s_lshl_b32 s54, s48, 6
  s_add_u32 s53, s53, s54
  s_lshl_b32 s53, s53, 10
  v_lshrrev_b32 v208, 3, v240
  v_lshlrev_b32 v208, 10, v208
  v_add_u32 v208, s53, v208
  v_and_b32 v209, 7, v240
  v_xor_b32 v209, v209, v204
  v_xor_b32 v210, 4, v209
  s_and_b32 s86, s49, 1
  s_lshl_b32 s53, s86, 15
  s_sub_u32 s54, 32768, s53
  v_lshl_add_u32 v190, v209, 4, v208
  v_add_u32 v190, s53, v190
  v_lshl_add_u32 v191, v210, 4, v208
  v_add_u32 v191, 7168, v191
  v_add_u32 v191, s53, v191
  v_lshl_add_u32 v192, v209, 4, v208
  v_add_u32 v192, 14336, v192
  v_add_u32 v192, s53, v192
  v_lshl_add_u32 v193, v210, 4, v208
  v_add_u32 v193, 21504, v193
  v_add_u32 v193, s53, v193
  v_lshl_add_u32 v194, v209, 4, v208
  v_add_u32 v194, s54, v194
  v_lshl_add_u32 v195, v210, 4, v208
  v_add_u32 v195, 7168, v195
  v_add_u32 v195, s54, v195
  v_lshl_add_u32 v196, v209, 4, v208
  v_add_u32 v196, 14336, v196
  v_add_u32 v196, s54, v196
  v_lshl_add_u32 v197, v210, 4, v208
  v_add_u32 v197, 21504, v197
  v_add_u32 v197, s54, v197
  s_lshl_b32 s53, s48, 17
  s_lshl_b32 s54, s49, 8
  s_add_u32 s53, s53, s54
  v_lshlrev_b32 v208, 13, v204
  v_add_u32 v208, s53, v208
  v_xor_b32 v209, v205, v204
  v_lshl_add_u32 v208, v209, 6, v208
  v_lshl_add_u32 v198, v206, 4, v208
  v_add_u32 v199, 31744, v198
  v_add_u32 v200, 63488, v198
  v_add_u32 v201, 95232, v198
  s_mul_i32 s53, s48, 44032
  s_lshr_b32 s54, s49, 1
  s_mul_i32 s54, s54, 192
  s_add_u32 s53, s53, s54
  s_lshl_b32 s54, s86, 6
  s_add_u32 s53, s53, s54
  v_lshrrev_b32 v208, 3, v240
  v_mul_u32_u24 v208, 2752, v208
  v_add_u32 v208, s53, v208
  v_and_b32 v209, 1, v240
  v_lshl_add_u32 v208, v209, 4, v208
  v_bfe_u32 v209, v240, 1, 2
  v_and_b32 v210, 1, v204
  v_xor_b32 v209, v209, v210
  v_lshl_add_u32 v202, v209, 5, v208
  v_xor_b32 v209, 2, v209
  v_lshl_add_u32 v203, v209, 5, v208
  v_add_u32 v203, 20992, v203
  s_mov_b32 s89, 0
  s_lshl_b32 s55, s48, 13
  s_lshl_b32 s56, s48, 12
  s_lshl_b32 s57, s48, 11
  s_waitcnt lgkmcnt(0)
  s_mov_b32 s20, s4
  s_and_b32 s21, s5, 0xffff
  s_mov_b32 s22, 0x200000
  s_mov_b32 s23, 0x20000
  s_mov_b32 s24, s10
  s_and_b32 s25, s11, 0xffff
  s_mov_b32 s26, 0x400000
  s_mov_b32 s27, 0x20000
  s_mov_b32 s28, s12
  s_and_b32 s29, s13, 0xffff
  s_mov_b32 s30, 0x158000
  s_mov_b32 s31, 0x20000
  s_mov_b32 s32, s14
  s_and_b32 s33, s15, 0xffff
  s_mov_b32 s34, 0x158000
  s_mov_b32 s35, 0x20000
  s_lshl_b32 s84, s50, 8
  s_lshl_b32 s54, s49, 3
  s_add_u32 s84, s84, s54
  s_lshl_b32 s54, s48, 1
  s_add_u32 s84, s84, s54
  s_lshl_b32 s53, s84, 10
  buffer_load_dwordx4 v[128:131], v241, s[20:23], s53 offen offset:0
  buffer_load_dwordx4 v[132:135], v241, s[20:23], s53 offen offset:1024
  s_add_u32 s58, s89, 0
  s_and_b32 s58, s58, 7
  s_lshl_b32 s58, s58, 7
  s_add_u32 m0, s55, 32768
  s_nop 0
  buffer_load_dwordx4 v190, s[20:23], s58 offen offset:0 lds
  buffer_load_dwordx4 v191, s[20:23], s58 offen offset:1024 lds
  buffer_load_dwordx4 v192, s[20:23], s58 offen offset:2048 lds
  buffer_load_dwordx4 v193, s[20:23], s58 offen offset:3072 lds
  s_add_u32 m0, s55, 36864
  s_nop 0
  buffer_load_dwordx4 v194, s[20:23], s58 offen offset:0 lds
  buffer_load_dwordx4 v195, s[20:23], s58 offen offset:1024 lds
  buffer_load_dwordx4 v196, s[20:23], s58 offen offset:2048 lds
  buffer_load_dwordx4 v197, s[20:23], s58 offen offset:3072 lds
  s_add_u32 s60, s89, 0
  s_and_b32 s60, s60, 7
  s_add_u32 m0, s56, 65536
  s_lshl_b32 s59, s60, 19
  buffer_load_dwordx4 v198, s[24:27], s59 offen offset:0 lds
  buffer_load_dwordx4 v199, s[24:27], s59 offen offset:1024 lds
  buffer_load_dwordx4 v200, s[24:27], s59 offen offset:2048 lds
  buffer_load_dwordx4 v201, s[24:27], s59 offen offset:3072 lds
  s_add_u32 m0, s57, 81920
  s_mul_i32 s60, s60, 176128
  buffer_load_dwordx4 v202, s[28:31], s60 offen offset:0 lds
  buffer_load_dwordx4 v203, s[28:31], s60 offen offset:1024 lds
  s_add_u32 m0, s57, 90112
  s_nop 0
  buffer_load_dwordx4 v202, s[32:35], s60 offen offset:0 lds
  buffer_load_dwordx4 v203, s[32:35], s60 offen offset:1024 lds
  s_getpc_b64 s[62:63]
KA_PC:
  s_sub_u32 s68, s62, KA_PC-ka_kernel
  s_subb_u32 s69, s63, 0
  s_and_b32 s69, s69, 0xffff
  s_mov_b32 s70, TEXT_END-ka_kernel
  s_mov_b32 s71, 0x20000
  s_lshl_b32 s53, s52, 2
  s_add_u32 s53, s53, s48
  s_lshl_b32 s53, s53, 13
  s_cmp_eq_u32 s50, 0
  s_cselect_b32 s53, s53, 0x7f000000
  v_lshlrev_b32 v208, 7, v240
  buffer_load_dword v249, v208, s[68:71], s53 offen
  s_lshl_b32 s53, s49, 19
  s_add_u32 s62, s6, s53
  s_addc_u32 s63, s7, 0
  s_mov_b32 s36, s62
  s_and_b32 s37, s63, 0xffff
  s_mov_b32 s38, 0x80000
  s_mov_b32 s39, 0x20000
  s_add_u32 s62, s8, s53
  s_addc_u32 s63, s9, 0
  s_sub_u32 s62, s62, 8192
  s_subb_u32 s63, s63, 0
  s_mov_b32 s40, s62
  s_and_b32 s41, s63, 0xffff
  s_mov_b32 s42, 0x82000
  s_mov_b32 s43, 0x20000
  s_mov_b32 s44, s16
  s_and_b32 s45, s17, 0xffff
  s_mov_b32 s46, 0x1560000
  s_mov_b32 s47, 0x20000
  v_lshlrev_b32 v211, 7, v240
  s_mov_b32 s87, 1
  s_lshl_b32 s53, s86, 8
  v_lshlrev_b32 v212, 3, v207
  v_add_u32 v213, s53, v212
  s_sub_u32 s53, 256, s53
  v_add_u32 v212, s53, v212
  s_bfe_u32 s53, s2, 0x20001
  s_mul_i32 s54, s53, 1441792
  s_add_u32 s62, s18, s54
  s_addc_u32 s63, s19, 0
  s_cmp_eq_u32 s53, 3
  s_cselect_b32 s62, s66, s62
  s_cselect_b32 s63, s67, s63
  s_mov_b32 s54, 1441792
  s_cselect_b32 s54, 1409024, s54
  s_cmp_eq_u32 s53, 2
  s_cselect_b32 s54, 1310720, s54
  s_mov_b32 s4, s62
  s_and_b32 s5, s63, 0xffff
  s_mov_b32 s6, s54
  s_mov_b32 s7, 0x20000
  s_mov_b32 s8, s72
  s_and_b32 s9, s73, 0xffff
  s_mov_b32 s10, 0x200000
  s_mov_b32 s11, 0x20000
  s_add_u32 s62, s16, 0x2000000
  s_addc_u32 s63, s17, 0
  s_mov_b32 s12, s62
  s_and_b32 s13, s63, 0xffff
  s_mov_b32 s14, 0x806000
  s_mov_b32 s15, 0x20000
  s_mov_b32 s16, s74
  s_and_b32 s17, s75, 0xffff
  s_mov_b32 s18, 0x100
  s_mov_b32 s19, 0x20000
  s_memrealtime s[62:63]
  s_lshl_b32 s53, s2, 10
  s_lshl_b32 s54, s48, 8
  s_add_u32 s53, s53, s54
  v_mov_b32 v209, 0
  s_waitcnt lgkmcnt(0)
  s_or_b32 s62, s62, 1
  v_mov_b32 v208, s62
  buffer_store_dword v208, v209, s[16:19], s53 offen sc1
  v_lshrrev_b32 v208, 1, v207
  v_xor_b32 v208, v208, v204
  v_lshlrev_b32 v209, 7, v207
  v_add_u32 v209, s55, v209
  v_xor_b32 v210, 0, v208
  v_lshl_add_u32 v210, v210, 4, v209
  v_add_u32 v176, 32768, v210
  v_xor_b32 v210, 4, v208
  v_lshl_add_u32 v210, v210, 4, v209
  v_add_u32 v177, 32768, v210
  v_lshl_add_u32 v208, v204, 3, v205
  v_lshlrev_b32 v209, 8, v208
  v_lshl_add_u32 v209, v206, 4, v209
  v_add_u32 v209, 65536, v209
  v_xor_b32 v210, 0, v205
  v_lshl_add_u32 v178, v210, 6, v209
  v_xor_b32 v210, 1, v205
  v_lshl_add_u32 v179, v210, 6, v209
  v_xor_b32 v210, 2, v205
  v_lshl_add_u32 v180, v210, 6, v209
  v_xor_b32 v210, 3, v205
  v_lshl_add_u32 v181, v210, 6, v209
  v_xor_b32 v210, s48, v205
  v_lshl_add_u32 v186, v210, 6, v209
  v_add_u32 v187, 8, v186
  v_lshlrev_b32 v209, 7, v208
  v_lshl_add_u32 v209, v206, 3, v209
  v_add_u32 v209, 81920, v209
  v_bfe_u32 v208, v240, 3, 2
  s_lshl_b32 s53, s86, 1
  v_xor_b32 v208, s53, v208
  v_xor_b32 v210, 0, v208
  v_lshl_add_u32 v182, v210, 5, v209
  v_xor_b32 v210, 1, v208
  v_lshl_add_u32 v183, v210, 5, v209
  v_xor_b32 v210, 2, v208
  v_lshl_add_u32 v184, v210, 5, v209
  v_xor_b32 v210, 3, v208
  v_lshl_add_u32 v185, v210, 5, v209
  v_xor_b32 v210, s48, v208
  v_lshl_add_u32 v188, v210, 5, v209
  v_add_u32 v189, 8192, v188
  s_lshl_b32 s53, s48, 11
  v_lshlrev_b32 v208, 8, v204
  v_add_u32 v208, s53, v208
  v_xor_b32 v209, v207, v204
  v_lshl_add_u32 v243, v209, 4, v208
  v_add_u32 v244, 8192, v243
  s_lshr_b32 s53, s48, 1
  s_lshl_b32 s53, s53, 3
  s_and_b32 s54, s48, 1
  s_lshl_b32 s54, s54, 1
  s_add_u32 s53, s53, s54
  s_lshl_b32 s53, s53, 8
  v_lshrrev_b32 v208, 1, v204
  v_lshlrev_b32 v208, 12, v208
  v_and_b32 v209, 1, v204
  v_lshl_add_u32 v208, v209, 10, v208
  v_lshl_add_u32 v208, v207, 4, v208
  v_add_u32 v245, s53, v208
  v_add_u32 v246, 8192, v245
  v_mul_u32_u24 v208, 2112, v205
  v_lshl_add_u32 v208, v206, 8, v208
  v_xor_b32 v209, v204, v206
  v_lshl_add_u32 v247, v209, 4, v208
  v_bfe_u32 v208, v240, 2, 3
  v_mul_u32_u24 v208, 1056, v208
  v_lshrrev_b32 v209, 5, v240
  v_lshl_add_u32 v208, v209, 9, v208
  v_lshl_add_u32 v248, v206, 3, v208
  s_mul_i32 s61, s48, 2112
  s_lshl_b32 s53, s48, 2
  s_add_u32 s53, s53, 5120
  v_add_u32 v254, s53, v241
  v_add_u32 v254, 0x20000, v254
  v_mov_b32 v242, 0xffff0000
  v_mov_b32 v236, 0x3f803f80
  v_mov_b32 v237, 0x3f803f80
  v_mov_b32 v238, 0x3f803f80
  v_mov_b32 v239, 0x3f803f80
  s_lshl_b32 s53, s50, 2
  s_add_u32 s53, s53, s48
  s_mul_i32 s65, s53, 700416
  v_mov_b32 v232, 0
  v_mov_b32 v233, 0
  v_mov_b32 v234, 0
  v_mov_b32 v235, 0
  s_nop 1
  s_mov_b32 s53, 0x3b000000
  s_mov_b32 s54, 0x3727c5ac
  v_mov_b32 v136, 0
  v_mov_b32 v137, 0
  v_mov_b32 v138, 0
  v_mov_b32 v139, 0
  v_lshrrev_b32 v162, 5, v240
  v_lshlrev_b32 v162, 3, v162
  s_waitcnt vmcnt(18)
  v_dot2c_f32_bf16 v136, v236, v128
  v_dot2c_f32_bf16 v138, v128, v128
  v_dot2c_f32_bf16 v137, v236, v132
  v_dot2c_f32_bf16 v139, v132, v132
  v_dot2c_f32_bf16 v136, v236, v129
  v_dot2c_f32_bf16 v138, v129, v129
  v_dot2c_f32_bf16 v137, v236, v133
  v_dot2c_f32_bf16 v139, v133, v133
  v_dot2c_f32_bf16 v136, v236, v130
  v_dot2c_f32_bf16 v138, v130, v130
  v_dot2c_f32_bf16 v137, v236, v134
  v_dot2c_f32_bf16 v139, v134, v134
  v_dot2c_f32_bf16 v136, v236, v131
  v_dot2c_f32_bf16 v138, v131, v131
  v_dot2c_f32_bf16 v137, v236, v135
  v_dot2c_f32_bf16 v139, v135, v135
  s_nop 3
  v_permlane32_swap_b32 v136, v137
  v_permlane32_swap_b32 v138, v139
  s_nop 0
  v_add_f32 v136, v136, v137
  v_add_f32 v138, v138, v139
  v_mov_b32 v137, v136
  v_mov_b32 v139, v138
  s_nop 1
  v_permlane16_swap_b32 v136, v137
  v_permlane16_swap_b32 v138, v139
  s_nop 0
  v_add_f32 v136, v136, v137
  v_add_f32 v138, v138, v139
  s_nop 0
  v_add_f32_dpp v136, v136, v136 row_ror:8 row_mask:0xf bank_mask:0xf
  v_add_f32_dpp v138, v138, v138 row_ror:8 row_mask:0xf bank_mask:0xf
  s_nop 0
  v_add_f32_dpp v136, v136, v136 row_ror:4 row_mask:0xf bank_mask:0xf
  v_add_f32_dpp v138, v138, v138 row_ror:4 row_mask:0xf bank_mask:0xf
  s_nop 0
  v_add_f32_dpp v136, v136, v136 row_ror:2 row_mask:0xf bank_mask:0xf
  v_add_f32_dpp v138, v138, v138 row_ror:2 row_mask:0xf bank_mask:0xf
  s_nop 0
  v_add_f32_dpp v136, v136, v136 row_ror:1 row_mask:0xf bank_mask:0xf
  v_add_f32_dpp v138, v138, v138 row_ror:1 row_mask:0xf bank_mask:0xf
  v_mul_f32 v136, s53, v136
  v_mul_f32 v138, s53, v138
  v_fma_f32 v138, -v136, v136, v138
  v_max_f32 v138, 0, v138
  v_cvt_pk_bf16_f32 v138, v138, v138
  v_and_b32 v138, v242, v138
  v_add_f32 v138, s54, v138
  v_cvt_pk_bf16_f32 v138, v138, v138
  v_and_b32 v138, v242, v138
  v_sqrt_f32 v138, v138
  s_nop 0
  v_cvt_pk_bf16_f32 v160, v138, v136
  v_mfma_f32_32x32x16_bf16 v[0:15], v[232:235], v[232:235], 0
  s_add_u32 s58, s89, 1
  s_and_b32 s58, s58, 7
  s_lshl_b32 s58, s58, 7
  s_add_u32 m0, s55, 131072
  s_nop 0
  buffer_load_dwordx4 v190, s[20:23], s58 offen offset:0 lds
  v_mfma_f32_32x32x16_bf16 v[16:31], v[232:235], v[232:235], 0
  buffer_load_dwordx4 v191, s[20:23], s58 offen offset:1024 lds
  v_mfma_f32_32x32x16_bf16 v[32:47], v[232:235], v[232:235], 0
  buffer_load_dwordx4 v192, s[20:23], s58 offen offset:2048 lds
  v_mfma_f32_32x32x16_bf16 v[48:63], v[232:235], v[232:235], 0
  buffer_load_dwordx4 v193, s[20:23], s58 offen offset:3072 lds
  v_mfma_f32_32x32x16_bf16 v[64:79], v[232:235], v[232:235], 0
  s_add_u32 m0, s55, 135168
  s_nop 0
  buffer_load_dwordx4 v194, s[20:23], s58 offen offset:0 lds
  v_mfma_f32_32x32x16_bf16 v[80:95], v[232:235], v[232:235], 0
  buffer_load_dwordx4 v195, s[20:23], s58 offen offset:1024 lds
  v_mfma_f32_32x32x16_bf16 v[96:111], v[232:235], v[232:235], 0
  buffer_load_dwordx4 v196, s[20:23], s58 offen offset:2048 lds
  v_mfma_f32_32x32x16_bf16 v[112:127], v[232:235], v[232:235], 0
  buffer_load_dwordx4 v197, s[20:23], s58 offen offset:3072 lds
  v_mfma_f32_32x32x16_bf16 a[128:143], v[232:235], v[232:235], 0
  s_add_u32 s60, s89, 1
  s_and_b32 s60, s60, 7
  s_add_u32 m0, s56, 98304
  s_lshl_b32 s59, s60, 19
  buffer_load_dwordx4 v198, s[24:27], s59 offen offset:0 lds
  v_mfma_f32_32x32x16_bf16 a[144:159], v[232:235], v[232:235], 0
  buffer_load_dwordx4 v199, s[24:27], s59 offen offset:1024 lds
  v_mfma_f32_32x32x16_bf16 a[160:175], v[232:235], v[232:235], 0
  buffer_load_dwordx4 v200, s[24:27], s59 offen offset:2048 lds
  v_mfma_f32_32x32x16_bf16 a[176:191], v[232:235], v[232:235], 0
  buffer_load_dwordx4 v201, s[24:27], s59 offen offset:3072 lds
  v_mfma_f32_32x32x16_bf16 a[192:207], v[232:235], v[232:235], 0
  s_add_u32 m0, s57, 114688
  s_mul_i32 s60, s60, 176128
  buffer_load_dwordx4 v202, s[28:31], s60 offen offset:0 lds
  v_mfma_f32_32x32x16_bf16 a[208:223], v[232:235], v[232:235], 0
  buffer_load_dwordx4 v203, s[28:31], s60 offen offset:1024 lds
  v_mfma_f32_32x32x16_bf16 a[224:239], v[232:235], v[232:235], 0
  s_add_u32 m0, s57, 122880
  s_nop 0
  buffer_load_dwordx4 v202, s[32:35], s60 offen offset:0 lds
  v_mfma_f32_32x32x16_bf16 a[240:255], v[232:235], v[232:235], 0
  buffer_load_dwordx4 v203, s[32:35], s60 offen offset:1024 lds
  s_mov_b32 s78, 0
  s_mov_b32 s79, 65536
  s_mov_b32 s80, 32768
  s_add_u32 s81, s55, 32768
  s_mov_b32 s82, 32768
  s_mov_b32 s83, 0xfffe8000
  s_waitcnt vmcnt(18)
  s_barrier
  ds_read_b128 v[128:131], v176 offset:0
  ds_read_b128 v[132:135], v176 offset:2048
  ds_read_b128 v[136:139], v176 offset:4096
  ds_read_b128 v[140:143], v176 offset:6144
  ds_read_b64_tr_b16 a[64:65], v186 offset:0
  ds_read_b64_tr_b16 a[66:67], v186 offset:1024
  ds_read_b64_tr_b16 a[68:69], v187 offset:0
  ds_read_b64_tr_b16 a[70:71], v187 offset:1024
  s_add_u32 s60, s89, 2
  s_and_b32 s60, s60, 7
  s_add_u32 m0, s56, 0
  s_lshl_b32 s59, s60, 19
  buffer_load_dwordx4 v198, s[24:27], s59 offen offset:0 lds
  ds_read_b64_tr_b16 a[72:73], v188 offset:0
  ds_read_b64_tr_b16 a[74:75], v188 offset:512
  ds_read_b64_tr_b16 a[76:77], v189 offset:0
  ds_read_b64_tr_b16 a[78:79], v189 offset:512
  buffer_load_dwordx4 v199, s[24:27], s59 offen offset:1024 lds
  s_waitcnt lgkmcnt(6)
  ds_read_b64_tr_b16 a[0:1], v178 offset:0
  ds_read_b64_tr_b16 a[2:3], v178 offset:1024
  ds_read_b64_tr_b16 a[4:5], v178 offset:8
  ds_read_b64_tr_b16 a[6:7], v178 offset:1032
  buffer_load_dwordx4 v200, s[24:27], s59 offen offset:2048 lds
  ds_read_b64_tr_b16 a[8:9], v179 offset:0
  ds_read_b64_tr_b16 a[10:11], v179 offset:1024
  ds_read_b64_tr_b16 a[12:13], v179 offset:8
  ds_read_b64_tr_b16 a[14:15], v179 offset:1032
  buffer_load_dwordx4 v201, s[24:27], s59 offen offset:3072 lds
  s_waitcnt lgkmcnt(6)
  ds_read_b64_tr_b16 a[16:17], v180 offset:0
  ds_read_b64_tr_b16 a[18:19], v180 offset:1024
  ds_read_b64_tr_b16 a[20:21], v180 offset:8
  ds_read_b64_tr_b16 a[22:23], v180 offset:1032
  s_add_u32 m0, s57, 16384
  s_mul_i32 s60, s60, 176128
  buffer_load_dwordx4 v202, s[28:31], s60 offen offset:0 lds
  ds_read_b64_tr_b16 a[24:25], v181 offset:0
  ds_read_b64_tr_b16 a[26:27], v181 offset:1024
  ds_read_b64_tr_b16 a[28:29], v181 offset:8
  ds_read_b64_tr_b16 a[30:31], v181 offset:1032
  buffer_load_dwordx4 v203, s[28:31], s60 offen offset:1024 lds
  s_waitcnt lgkmcnt(6)
  ds_read_b64_tr_b16 a[48:49], v184 offset:0
  ds_read_b64_tr_b16 a[50:51], v184 offset:512
  ds_read_b64_tr_b16 a[52:53], v184 offset:8192
  ds_read_b64_tr_b16 a[54:55], v184 offset:8704
  s_add_u32 m0, s57, 24576
  s_nop 0
  buffer_load_dwordx4 v202, s[32:35], s60 offen offset:0 lds
  ds_read_b64_tr_b16 a[56:57], v185 offset:0
  ds_read_b64_tr_b16 a[58:59], v185 offset:512
  ds_read_b64_tr_b16 a[60:61], v185 offset:8192
  ds_read_b64_tr_b16 a[62:63], v185 offset:8704
  buffer_load_dwordx4 v203, s[32:35], s60 offen offset:1024 lds
  s_waitcnt lgkmcnt(6)
  ds_read_b64_tr_b16 a[32:33], v182 offset:0
  ds_read_b64_tr_b16 a[34:35], v182 offset:512
  ds_read_b64_tr_b16 a[36:37], v182 offset:8192
  ds_read_b64_tr_b16 a[38:39], v182 offset:8704
  ds_read_b64_tr_b16 a[40:41], v183 offset:0
  ds_read_b64_tr_b16 a[42:43], v183 offset:512
  ds_read_b64_tr_b16 a[44:45], v183 offset:8192
  ds_read_b64_tr_b16 a[46:47], v183 offset:8704
  s_waitcnt lgkmcnt(6)
  s_add_u32 s58, s89, 2
  s_and_b32 s58, s58, 7
  s_lshl_b32 s58, s58, 7
  s_add_u32 s89, s89, 3
  s_and_b32 s89, s89, 7
  s_lshl_b32 s59, s89, 19
  s_mul_i32 s60, s89, 176128
  s_waitcnt lgkmcnt(6)
.p2align 6
KA_GEMM:
  v_mfma_f32_16x16x32_bf16 a[240:243], a[64:67], v[236:239], a[240:243]
  ds_read_b128 v[144:147], v177 offset:0
  v_mfma_f32_16x16x32_bf16 a[244:247], a[68:71], v[236:239], a[244:247]
  ds_read_b128 v[148:151], v177 offset:2048
  v_mfma_f32_16x16x32_bf16 a[248:251], a[72:75], v[236:239], a[248:251]
  ds_read_b128 v[152:155], v177 offset:4096
  v_mfma_f32_16x16x32_bf16 a[252:255], a[76:79], v[236:239], a[252:255]
  ds_read_b128 v[156:159], v177 offset:6144
  v_xor_b32 v176, 0x28000, v176
  v_mfma_f32_16x16x32_bf16 v[0:3], a[0:3], v[128:131], v[0:3]
  ds_read_b64_tr_b16 a[92:93], v186 offset:8192
  v_xor_b32 v177, 0x28000, v177
  v_mfma_f32_16x16x32_bf16 v[4:7], a[0:3], v[132:135], v[4:7]
  ds_read_b64_tr_b16 a[94:95], v186 offset:9216
  v_add_u32 v186, s80, v186
  v_mfma_f32_16x16x32_bf16 v[8:11], a[0:3], v[136:139], v[8:11]
  ds_read_b64_tr_b16 a[96:97], v187 offset:8192
  v_mfma_f32_16x16x32_bf16 v[12:15], a[0:3], v[140:143], v[12:15]
  ds_read_b64_tr_b16 a[0:1], v178 offset:8192
  v_mfma_f32_16x16x32_bf16 v[16:19], a[4:7], v[128:131], v[16:19]
  ds_read_b64_tr_b16 a[2:3], v178 offset:9216
  v_mfma_f32_16x16x32_bf16 v[20:23], a[4:7], v[132:135], v[20:23]
  ds_read_b64_tr_b16 a[98:99], v187 offset:9216
  v_add_u32 v187, s80, v187
  v_mfma_f32_16x16x32_bf16 v[24:27], a[4:7], v[136:139], v[24:27]
  ds_read_b64_tr_b16 a[100:101], v188 offset:4096
  v_mfma_f32_16x16x32_bf16 v[28:31], a[4:7], v[140:143], v[28:31]
  ds_read_b64_tr_b16 a[4:5], v178 offset:8200
  v_mfma_f32_16x16x32_bf16 v[32:35], a[8:11], v[128:131], v[32:35]
  s_waitcnt lgkmcnt(6)
  ds_read_b64_tr_b16 a[6:7], v178 offset:9224
  v_add_u32 v178, s80, v178
  v_mfma_f32_16x16x32_bf16 v[36:39], a[8:11], v[132:135], v[36:39]
  s_add_u32 m0, s81, 0
  ds_read_b64_tr_b16 a[102:103], v188 offset:4608
  v_add_u32 v188, s80, v188
  v_mfma_f32_16x16x32_bf16 v[40:43], a[8:11], v[136:139], v[40:43]
  buffer_load_dwordx4 v190, s[20:23], s58 offen offset:0 lds
  v_mfma_f32_16x16x32_bf16 v[44:47], a[8:11], v[140:143], v[44:47]
  ds_read_b64_tr_b16 a[8:9], v179 offset:8192
  v_mfma_f32_16x16x32_bf16 v[48:51], a[12:15], v[128:131], v[48:51]
  ds_read_b64_tr_b16 a[10:11], v179 offset:9216
  v_mfma_f32_16x16x32_bf16 v[52:55], a[12:15], v[132:135], v[52:55]
  ds_read_b64_tr_b16 a[104:105], v189 offset:4096
  v_mfma_f32_16x16x32_bf16 v[56:59], a[12:15], v[136:139], v[56:59]
  buffer_load_dwordx4 v191, s[20:23], s58 offen offset:1024 lds
  v_mfma_f32_16x16x32_bf16 v[60:63], a[12:15], v[140:143], v[60:63]
  ds_read_b64_tr_b16 a[12:13], v179 offset:8200
  v_mfma_f32_16x16x32_bf16 v[64:67], a[16:19], v[128:131], v[64:67]
  ds_read_b64_tr_b16 a[14:15], v179 offset:9224
  v_add_u32 v179, s80, v179
  v_mfma_f32_16x16x32_bf16 v[68:71], a[16:19], v[132:135], v[68:71]
  ds_read_b64_tr_b16 a[106:107], v189 offset:4608
  v_add_u32 v189, s80, v189
  v_mfma_f32_16x16x32_bf16 v[72:75], a[16:19], v[136:139], v[72:75]
  buffer_load_dwordx4 v192, s[20:23], s58 offen offset:2048 lds
  v_mfma_f32_16x16x32_bf16 v[76:79], a[16:19], v[140:143], v[76:79]
  ds_read_b64_tr_b16 a[16:17], v180 offset:8192
  v_mfma_f32_16x16x32_bf16 v[80:83], a[20:23], v[128:131], v[80:83]
  ds_read_b64_tr_b16 a[18:19], v180 offset:9216
  v_mfma_f32_16x16x32_bf16 v[84:87], a[20:23], v[132:135], v[84:87]
  ds_read_b64_tr_b16 a[108:109], v184 offset:4096
  v_mfma_f32_16x16x32_bf16 v[88:91], a[20:23], v[136:139], v[88:91]
  buffer_load_dwordx4 v193, s[20:23], s58 offen offset:3072 lds
  v_mfma_f32_16x16x32_bf16 v[92:95], a[20:23], v[140:143], v[92:95]
  ds_read_b64_tr_b16 a[20:21], v180 offset:8200
  v_mfma_f32_16x16x32_bf16 v[96:99], a[24:27], v[128:131], v[96:99]
  s_waitcnt lgkmcnt(6)
  ds_read_b64_tr_b16 a[22:23], v180 offset:9224
  v_add_u32 v180, s80, v180
  v_mfma_f32_16x16x32_bf16 v[100:103], a[24:27], v[132:135], v[100:103]
  s_add_u32 m0, s81, 4096
  ds_read_b64_tr_b16 a[110:111], v184 offset:4608
  v_mfma_f32_16x16x32_bf16 v[104:107], a[24:27], v[136:139], v[104:107]
  buffer_load_dwordx4 v194, s[20:23], s58 offen offset:0 lds
  v_mfma_f32_16x16x32_bf16 v[108:111], a[24:27], v[140:143], v[108:111]
  ds_read_b64_tr_b16 a[24:25], v181 offset:8192
  v_mfma_f32_16x16x32_bf16 v[112:115], a[28:31], v[128:131], v[112:115]
  ds_read_b64_tr_b16 a[26:27], v181 offset:9216
  v_mfma_f32_16x16x32_bf16 v[116:119], a[28:31], v[132:135], v[116:119]
  ds_read_b64_tr_b16 a[112:113], v184 offset:12288
  v_mfma_f32_16x16x32_bf16 v[120:123], a[28:31], v[136:139], v[120:123]
  buffer_load_dwordx4 v195, s[20:23], s58 offen offset:1024 lds
  v_mfma_f32_16x16x32_bf16 v[124:127], a[28:31], v[140:143], v[124:127]
  ds_read_b64_tr_b16 a[28:29], v181 offset:8200
  v_mfma_f32_16x16x32_bf16 a[192:195], a[48:51], v[128:131], a[192:195]
  ds_read_b64_tr_b16 a[30:31], v181 offset:9224
  v_add_u32 v181, s80, v181
  v_mfma_f32_16x16x32_bf16 a[196:199], a[48:51], v[132:135], a[196:199]
  ds_read_b64_tr_b16 a[114:115], v184 offset:12800
  v_add_u32 v184, s80, v184
  v_mfma_f32_16x16x32_bf16 a[200:203], a[52:55], v[128:131], a[200:203]
  ds_read_b64_tr_b16 a[116:117], v185 offset:4096
  v_mfma_f32_16x16x32_bf16 a[204:207], a[52:55], v[132:135], a[204:207]
  ds_read_b64_tr_b16 a[118:119], v185 offset:4608
  v_mfma_f32_16x16x32_bf16 a[208:211], a[56:59], v[128:131], a[208:211]
  buffer_load_dwordx4 v196, s[20:23], s58 offen offset:2048 lds
  v_mfma_f32_16x16x32_bf16 a[212:215], a[56:59], v[132:135], a[212:215]
  ds_read_b64_tr_b16 a[88:89], v182 offset:12288
  v_mfma_f32_16x16x32_bf16 a[216:219], a[60:63], v[128:131], a[216:219]
  ds_read_b64_tr_b16 a[90:91], v182 offset:12800
  v_mfma_f32_16x16x32_bf16 a[220:223], a[60:63], v[132:135], a[220:223]
  s_waitcnt lgkmcnt(6)
  ds_read_b64_tr_b16 a[60:61], v185 offset:12288
  v_mfma_f32_16x16x32_bf16 a[128:131], a[32:35], v[128:131], a[128:131]
  ds_read_b64_tr_b16 a[62:63], v185 offset:12800
  v_add_u32 v185, s80, v185
  v_mfma_f32_16x16x32_bf16 a[132:135], a[32:35], v[132:135], a[132:135]
  ds_read_b64_tr_b16 a[80:81], v183 offset:4096
  v_mfma_f32_16x16x32_bf16 a[136:139], a[32:35], v[136:139], a[136:139]
  buffer_load_dwordx4 v197, s[20:23], s58 offen offset:3072 lds
  v_mfma_f32_16x16x32_bf16 a[140:143], a[32:35], v[140:143], a[140:143]
  ds_read_b64_tr_b16 a[32:33], v182 offset:4096
  v_mfma_f32_16x16x32_bf16 a[144:147], a[36:39], v[128:131], a[144:147]
  ds_read_b64_tr_b16 a[34:35], v182 offset:4608
  v_add_u32 v182, s80, v182
  v_mfma_f32_16x16x32_bf16 a[148:151], a[36:39], v[132:135], a[148:151]
  ds_read_b64_tr_b16 a[82:83], v183 offset:4608
  v_mfma_f32_16x16x32_bf16 a[152:155], a[36:39], v[136:139], a[152:155]
  ds_read_b64_tr_b16 a[84:85], v183 offset:12288
  v_mfma_f32_16x16x32_bf16 a[156:159], a[36:39], v[140:143], a[156:159]
  ds_read_b64_tr_b16 a[86:87], v183 offset:12800
  v_add_u32 v183, s80, v183
  v_mfma_f32_16x16x32_bf16 a[160:163], a[40:43], v[128:131], a[160:163]
  v_mfma_f32_16x16x32_bf16 a[164:167], a[40:43], v[132:135], a[164:167]
  v_mfma_f32_16x16x32_bf16 a[168:171], a[40:43], v[136:139], a[168:171]
  v_mfma_f32_16x16x32_bf16 a[172:175], a[40:43], v[140:143], a[172:175]
  s_add_u32 s58, s58, 128
  v_mfma_f32_16x16x32_bf16 a[176:179], a[44:47], v[128:131], a[176:179]
  s_and_b32 s58, s58, 1023
  v_mfma_f32_16x16x32_bf16 a[180:183], a[44:47], v[132:135], a[180:183]
  s_xor_b32 s81, s81, 0x28000
  v_mfma_f32_16x16x32_bf16 a[184:187], a[44:47], v[136:139], a[184:187]
  s_cmp_ge_u32 s78, 5
  v_mfma_f32_16x16x32_bf16 a[188:191], a[44:47], v[140:143], a[188:191]
  s_cselect_b32 s58, 0x7f000000, s58
  s_waitcnt vmcnt(16) lgkmcnt(0)
  s_barrier
  v_mfma_f32_16x16x32_bf16 a[240:243], a[92:95], v[236:239], a[240:243]
  ds_read_b128 v[128:131], v176 offset:0
  v_mfma_f32_16x16x32_bf16 a[244:247], a[96:99], v[236:239], a[244:247]
  s_add_u32 m0, s56, s79
  ds_read_b128 v[132:135], v176 offset:2048
  v_mfma_f32_16x16x32_bf16 a[248:251], a[100:103], v[236:239], a[248:251]
  buffer_load_dwordx4 v198, s[24:27], s59 offen offset:0 lds
  v_mfma_f32_16x16x32_bf16 a[252:255], a[104:107], v[236:239], a[252:255]
  ds_read_b128 v[136:139], v176 offset:4096
  v_mfma_f32_16x16x32_bf16 v[0:3], a[0:3], v[144:147], v[0:3]
  ds_read_b128 v[140:143], v176 offset:6144
  v_mfma_f32_16x16x32_bf16 v[4:7], a[0:3], v[148:151], v[4:7]
  ds_read_b64_tr_b16 a[64:65], v186 offset:0
  v_mfma_f32_16x16x32_bf16 v[8:11], a[0:3], v[152:155], v[8:11]
  buffer_load_dwordx4 v199, s[24:27], s59 offen offset:1024 lds
  v_mfma_f32_16x16x32_bf16 v[12:15], a[0:3], v[156:159], v[12:15]
  ds_read_b64_tr_b16 a[0:1], v178 offset:0
  v_mfma_f32_16x16x32_bf16 v[16:19], a[4:7], v[144:147], v[16:19]
  ds_read_b64_tr_b16 a[2:3], v178 offset:1024
  v_mfma_f32_16x16x32_bf16 v[20:23], a[4:7], v[148:151], v[20:23]
  ds_read_b64_tr_b16 a[66:67], v186 offset:1024
  v_mfma_f32_16x16x32_bf16 v[24:27], a[4:7], v[152:155], v[24:27]
  buffer_load_dwordx4 v200, s[24:27], s59 offen offset:2048 lds
  v_mfma_f32_16x16x32_bf16 v[28:31], a[4:7], v[156:159], v[28:31]
  ds_read_b64_tr_b16 a[4:5], v178 offset:8
  v_mfma_f32_16x16x32_bf16 v[32:35], a[8:11], v[144:147], v[32:35]
  s_waitcnt lgkmcnt(6)
  ds_read_b64_tr_b16 a[6:7], v178 offset:1032
  v_mfma_f32_16x16x32_bf16 v[36:39], a[8:11], v[148:151], v[36:39]
  ds_read_b64_tr_b16 a[68:69], v187 offset:0
  v_mfma_f32_16x16x32_bf16 v[40:43], a[8:11], v[152:155], v[40:43]
  buffer_load_dwordx4 v201, s[24:27], s59 offen offset:3072 lds
  v_mfma_f32_16x16x32_bf16 v[44:47], a[8:11], v[156:159], v[44:47]
  ds_read_b64_tr_b16 a[8:9], v179 offset:0
  v_mfma_f32_16x16x32_bf16 v[48:51], a[12:15], v[144:147], v[48:51]
  s_add_u32 s53, s57, s79
  ds_read_b64_tr_b16 a[10:11], v179 offset:1024
  v_mfma_f32_16x16x32_bf16 v[52:55], a[12:15], v[148:151], v[52:55]
  s_add_u32 m0, s53, 16384
  ds_read_b64_tr_b16 a[70:71], v187 offset:1024
  v_mfma_f32_16x16x32_bf16 v[56:59], a[12:15], v[152:155], v[56:59]
  buffer_load_dwordx4 v202, s[28:31], s60 offen offset:0 lds
  v_mfma_f32_16x16x32_bf16 v[60:63], a[12:15], v[156:159], v[60:63]
  ds_read_b64_tr_b16 a[12:13], v179 offset:8
  v_mfma_f32_16x16x32_bf16 v[64:67], a[16:19], v[144:147], v[64:67]
  ds_read_b64_tr_b16 a[14:15], v179 offset:1032
  v_mfma_f32_16x16x32_bf16 v[68:71], a[16:19], v[148:151], v[68:71]
  ds_read_b64_tr_b16 a[72:73], v188 offset:0
  v_mfma_f32_16x16x32_bf16 v[72:75], a[16:19], v[152:155], v[72:75]
  buffer_load_dwordx4 v203, s[28:31], s60 offen offset:1024 lds
  v_mfma_f32_16x16x32_bf16 v[76:79], a[16:19], v[156:159], v[76:79]
  ds_read_b64_tr_b16 a[16:17], v180 offset:0
  v_mfma_f32_16x16x32_bf16 v[80:83], a[20:23], v[144:147], v[80:83]
  ds_read_b64_tr_b16 a[18:19], v180 offset:1024
  v_mfma_f32_16x16x32_bf16 v[84:87], a[20:23], v[148:151], v[84:87]
  s_add_u32 m0, s53, 24576
  ds_read_b64_tr_b16 a[74:75], v188 offset:512
  v_mfma_f32_16x16x32_bf16 v[88:91], a[20:23], v[152:155], v[88:91]
  buffer_load_dwordx4 v202, s[32:35], s60 offen offset:0 lds
  v_mfma_f32_16x16x32_bf16 v[92:95], a[20:23], v[156:159], v[92:95]
  ds_read_b64_tr_b16 a[20:21], v180 offset:8
  v_mfma_f32_16x16x32_bf16 v[96:99], a[24:27], v[144:147], v[96:99]
  s_waitcnt lgkmcnt(6)
  ds_read_b64_tr_b16 a[22:23], v180 offset:1032
  v_mfma_f32_16x16x32_bf16 v[100:103], a[24:27], v[148:151], v[100:103]
  ds_read_b64_tr_b16 a[76:77], v189 offset:0
  v_mfma_f32_16x16x32_bf16 v[104:107], a[24:27], v[152:155], v[104:107]
  buffer_load_dwordx4 v203, s[32:35], s60 offen offset:1024 lds
  v_mfma_f32_16x16x32_bf16 v[108:111], a[24:27], v[156:159], v[108:111]
  ds_read_b64_tr_b16 a[24:25], v181 offset:0
  v_mfma_f32_16x16x32_bf16 v[112:115], a[28:31], v[144:147], v[112:115]
  ds_read_b64_tr_b16 a[26:27], v181 offset:1024
  v_mfma_f32_16x16x32_bf16 v[116:119], a[28:31], v[148:151], v[116:119]
  ds_read_b64_tr_b16 a[78:79], v189 offset:512
  v_mfma_f32_16x16x32_bf16 v[120:123], a[28:31], v[152:155], v[120:123]
  ds_read_b64_tr_b16 a[48:49], v184 offset:0
  v_mfma_f32_16x16x32_bf16 v[124:127], a[28:31], v[156:159], v[124:127]
  ds_read_b64_tr_b16 a[28:29], v181 offset:8
  v_mfma_f32_16x16x32_bf16 a[192:195], a[108:111], v[144:147], a[192:195]
  ds_read_b64_tr_b16 a[30:31], v181 offset:1032
  v_mfma_f32_16x16x32_bf16 a[196:199], a[108:111], v[148:151], a[196:199]
  ds_read_b64_tr_b16 a[50:51], v184 offset:512
  v_mfma_f32_16x16x32_bf16 a[200:203], a[112:115], v[144:147], a[200:203]
  ds_read_b64_tr_b16 a[52:53], v184 offset:8192
  v_mfma_f32_16x16x32_bf16 a[204:207], a[112:115], v[148:151], a[204:207]
  ds_read_b64_tr_b16 a[54:55], v184 offset:8704
  v_mfma_f32_16x16x32_bf16 a[208:211], a[116:119], v[144:147], a[208:211]
  ds_read_b64_tr_b16 a[56:57], v185 offset:0
  v_mfma_f32_16x16x32_bf16 a[212:215], a[116:119], v[148:151], a[212:215]
  ds_read_b64_tr_b16 a[58:59], v185 offset:512
  v_mfma_f32_16x16x32_bf16 a[216:219], a[60:63], v[144:147], a[216:219]
  ds_read_b64_tr_b16 a[36:37], v182 offset:8192
  v_mfma_f32_16x16x32_bf16 a[220:223], a[60:63], v[148:151], a[220:223]
  s_waitcnt lgkmcnt(6)
  ds_read_b64_tr_b16 a[60:61], v185 offset:8192
  v_mfma_f32_16x16x32_bf16 a[128:131], a[32:35], v[144:147], a[128:131]
  ds_read_b64_tr_b16 a[62:63], v185 offset:8704
  v_mfma_f32_16x16x32_bf16 a[132:135], a[32:35], v[148:151], a[132:135]
  ds_read_b64_tr_b16 a[38:39], v182 offset:8704
  v_mfma_f32_16x16x32_bf16 a[136:139], a[32:35], v[152:155], a[136:139]
  s_add_u32 s89, s89, 1
  ds_read_b64_tr_b16 a[40:41], v183 offset:0
  v_mfma_f32_16x16x32_bf16 a[140:143], a[32:35], v[156:159], a[140:143]
  s_and_b32 s89, s89, 7
  ds_read_b64_tr_b16 a[32:33], v182 offset:0
  v_mfma_f32_16x16x32_bf16 a[144:147], a[88:91], v[144:147], a[144:147]
  s_cmp_ge_u32 s78, 4
  ds_read_b64_tr_b16 a[34:35], v182 offset:512
  v_mfma_f32_16x16x32_bf16 a[148:151], a[88:91], v[148:151], a[148:151]
  s_cselect_b32 s53, 64, s89
  ds_read_b64_tr_b16 a[42:43], v183 offset:512
  v_mfma_f32_16x16x32_bf16 a[152:155], a[88:91], v[152:155], a[152:155]
  s_lshl_b32 s59, s53, 19
  ds_read_b64_tr_b16 a[44:45], v183 offset:8192
  v_mfma_f32_16x16x32_bf16 a[156:159], a[88:91], v[156:159], a[156:159]
  s_mul_i32 s60, s53, 176128
  ds_read_b64_tr_b16 a[46:47], v183 offset:8704
  v_mfma_f32_16x16x32_bf16 a[160:163], a[80:83], v[144:147], a[160:163]
  s_cmp_eq_u32 s79, 65536
  v_mfma_f32_16x16x32_bf16 a[164:167], a[80:83], v[148:151], a[164:167]
  s_cselect_b32 s80, s83, 65536
  v_mfma_f32_16x16x32_bf16 a[168:171], a[80:83], v[152:155], a[168:171]
  s_cselect_b32 s54, 98304, 0
  v_mfma_f32_16x16x32_bf16 a[172:175], a[80:83], v[156:159], a[172:175]
  s_cmp_eq_u32 s79, 0
  v_mfma_f32_16x16x32_bf16 a[176:179], a[84:87], v[144:147], a[176:179]
  s_cselect_b32 s80, s82, s80
  v_mfma_f32_16x16x32_bf16 a[180:183], a[84:87], v[148:151], a[180:183]
  s_cselect_b32 s79, 65536, s54
  v_mfma_f32_16x16x32_bf16 a[184:187], a[84:87], v[152:155], a[184:187]
  s_add_u32 s78, s78, 1
  v_mfma_f32_16x16x32_bf16 a[188:191], a[84:87], v[156:159], a[188:191]
  s_cmp_lt_u32 s78, 8
  s_waitcnt lgkmcnt(0)
  s_cbranch_scc0 KA_GEND
  s_cmp_lg_u32 s78, s87
  s_cbranch_scc1 KA_GEMM
  s_branch KA_GSIDE
KA_GEND:
  v_lshlrev_b32 v215, 4, v204
  v_add_u32 v215, 135168, v215
  v_add_u32 v209, s55, v215
  s_mov_b32 s62, 0x3e0293ee
  s_mov_b32 s89, 0
  s_waitcnt vmcnt(0) lgkmcnt(0)
  ds_write_b128 v209, a[240:243] offset:0
  ds_write_b128 v209, a[244:247] offset:64
  ds_write_b128 v209, a[248:251] offset:128
  ds_write_b128 v209, a[252:255] offset:192
  v_mfma_f32_32x32x16_bf16 a[0:15], v[232:235], v[232:235], 0
  v_mfma_f32_32x32x16_bf16 a[16:31], v[232:235], v[232:235], 0
  v_mfma_f32_32x32x16_bf16 a[32:47], v[232:235], v[232:235], 0
  v_mfma_f32_32x32x16_bf16 a[48:63], v[232:235], v[232:235], 0
  v_mfma_f32_32x32x16_bf16 a[64:79], v[232:235], v[232:235], 0
  v_mfma_f32_32x32x16_bf16 a[80:95], v[232:235], v[232:235], 0
  v_mfma_f32_32x32x16_bf16 a[96:111], v[232:235], v[232:235], 0
  v_mfma_f32_32x32x16_bf16 a[112:127], v[232:235], v[232:235], 0
KA_STC:
  v_xor_b32 v172, s88, v165
  v_xor_b32 v173, s88, v167
  v_xor_b32 v174, s88, v169
  v_xor_b32 v175, s88, v171
  v_or3_b32 v172, v172, v173, v174
  v_or_b32 v172, v172, v175
  v_cmp_ne_u32 vcc, 0, v172
  v_lshlrev_b32 v172, 16, v164
  v_lshlrev_b32 v173, 16, v166
  v_lshlrev_b32 v174, 16, v168
  v_lshlrev_b32 v175, 16, v170
  s_cbranch_vccnz KA_STW
KA_STOK:
  v_rcp_f32 v172, v172
  v_rcp_f32 v173, v173
  v_rcp_f32 v174, v174
  v_rcp_f32 v175, v175
  v_and_b32 v164, v242, v164
  v_and_b32 v166, v242, v166
  v_and_b32 v168, v242, v168
  v_and_b32 v170, v242, v170
  v_sub_f32 v217, 0, v164
  v_sub_f32 v219, 0, v166
  v_sub_f32 v221, 0, v168
  v_sub_f32 v223, 0, v170
  v_sub_f32 v225, 0, v164
  v_sub_f32 v227, 0, v166
  v_sub_f32 v229, 0, v168
  v_sub_f32 v231, 0, v170
  v_mul_f32 v216, v172, v172
  v_mul_f32 v218, v173, v173
  v_mul_f32 v220, v174, v174
  v_mul_f32 v222, v175, v175
  v_mul_f32 v224, s62, v172
  v_mul_f32 v226, s62, v173
  v_mul_f32 v228, s62, v174
  v_mul_f32 v230, s62, v175
  s_waitcnt lgkmcnt(0)
  s_barrier
  ds_read_b128 v[176:179], v215 offset:0
  ds_read_b128 v[180:183], v215 offset:64
  ds_read_b128 v[184:187], v215 offset:8192
  ds_read_b128 v[188:191], v215 offset:8256
  ds_read_b128 v[192:195], v215 offset:16384
  ds_read_b128 v[196:199], v215 offset:16448
  ds_read_b128 v[200:203], v215 offset:24576
  ds_read_b128 v[204:207], v215 offset:24640
  s_mov_b32 s64, 0
  s_add_u32 m0, s61, 0
  s_nop 0
  buffer_load_dwordx4 v243, s[36:39], s64 offen offset:0 lds
  buffer_load_dwordx4 v243, s[36:39], s64 offen offset:1024 lds
  s_add_u32 m0, s61, 8448
  s_nop 0
  buffer_load_dwordx4 v244, s[36:39], s64 offen offset:0 lds
  buffer_load_dwordx4 v244, s[36:39], s64 offen offset:1024 lds
  s_waitcnt lgkmcnt(0)
  v_pk_fma_f32 v[0:1], v[176:177], v[224:225], v[0:1] op_sel:[0,1,0] op_sel_hi:[1,1,1]
  v_pk_fma_f32 v[2:3], v[178:179], v[224:225], v[2:3] op_sel:[0,1,0] op_sel_hi:[1,1,1]
  v_pk_fma_f32 v[16:17], v[180:181], v[224:225], v[16:17] op_sel:[0,1,0] op_sel_hi:[1,1,1]
  v_pk_fma_f32 v[18:19], v[182:183], v[224:225], v[18:19] op_sel:[0,1,0] op_sel_hi:[1,1,1]
  v_pk_fma_f32 v[32:33], v[184:185], v[224:225], v[32:33] op_sel:[0,1,0] op_sel_hi:[1,1,1]
  v_pk_fma_f32 v[34:35], v[186:187], v[224:225], v[34:35] op_sel:[0,1,0] op_sel_hi:[1,1,1]
  v_pk_fma_f32 v[48:49], v[188:189], v[224:225], v[48:49] op_sel:[0,1,0] op_sel_hi:[1,1,1]
  v_pk_fma_f32 v[50:51], v[190:191], v[224:225], v[50:51] op_sel:[0,1,0] op_sel_hi:[1,1,1]
  v_pk_fma_f32 v[64:65], v[192:193], v[224:225], v[64:65] op_sel:[0,1,0] op_sel_hi:[1,1,1]
  v_pk_fma_f32 v[66:67], v[194:195], v[224:225], v[66:67] op_sel:[0,1,0] op_sel_hi:[1,1,1]
  v_pk_fma_f32 v[80:81], v[196:197], v[224:225], v[80:81] op_sel:[0,1,0] op_sel_hi:[1,1,1]
  s_add_u32 m0, s61, 16896
  s_nop 0
  buffer_load_dwordx4 v246, s[40:43], s64 offen offset:0 lds
  v_pk_fma_f32 v[82:83], v[198:199], v[224:225], v[82:83] op_sel:[0,1,0] op_sel_hi:[1,1,1]
  v_pk_fma_f32 v[96:97], v[200:201], v[224:225], v[96:97] op_sel:[0,1,0] op_sel_hi:[1,1,1]
  v_pk_fma_f32 v[98:99], v[202:203], v[224:225], v[98:99] op_sel:[0,1,0] op_sel_hi:[1,1,1]
  v_pk_fma_f32 v[112:113], v[204:205], v[224:225], v[112:113] op_sel:[0,1,0] op_sel_hi:[1,1,1]
  v_pk_fma_f32 v[114:115], v[206:207], v[224:225], v[114:115] op_sel:[0,1,0] op_sel_hi:[1,1,1]
  v_pk_fma_f32 v[4:5], v[176:177], v[226:227], v[4:5] op_sel:[0,1,0] op_sel_hi:[1,1,1]
  v_pk_fma_f32 v[6:7], v[178:179], v[226:227], v[6:7] op_sel:[0,1,0] op_sel_hi:[1,1,1]
  v_pk_fma_f32 v[20:21], v[180:181], v[226:227], v[20:21] op_sel:[0,1,0] op_sel_hi:[1,1,1]
  v_pk_fma_f32 v[22:23], v[182:183], v[226:227], v[22:23] op_sel:[0,1,0] op_sel_hi:[1,1,1]
  v_pk_fma_f32 v[36:37], v[184:185], v[226:227], v[36:37] op_sel:[0,1,0] op_sel_hi:[1,1,1]
  v_pk_fma_f32 v[38:39], v[186:187], v[226:227], v[38:39] op_sel:[0,1,0] op_sel_hi:[1,1,1]
  s_add_u32 m0, s61, 17696
  s_nop 0
  buffer_load_dwordx4 v246, s[40:43], s64 offen offset:256 lds
  v_pk_fma_f32 v[52:53], v[188:189], v[226:227], v[52:53] op_sel:[0,1,0] op_sel_hi:[1,1,1]
  v_pk_fma_f32 v[54:55], v[190:191], v[226:227], v[54:55] op_sel:[0,1,0] op_sel_hi:[1,1,1]
  v_pk_fma_f32 v[68:69], v[192:193], v[226:227], v[68:69] op_sel:[0,1,0] op_sel_hi:[1,1,1]
  v_pk_fma_f32 v[70:71], v[194:195], v[226:227], v[70:71] op_sel:[0,1,0] op_sel_hi:[1,1,1]
  v_pk_fma_f32 v[84:85], v[196:197], v[226:227], v[84:85] op_sel:[0,1,0] op_sel_hi:[1,1,1]
  v_pk_fma_f32 v[86:87], v[198:199], v[226:227], v[86:87] op_sel:[0,1,0] op_sel_hi:[1,1,1]
  v_pk_fma_f32 v[100:101], v[200:201], v[226:227], v[100:101] op_sel:[0,1,0] op_sel_hi:[1,1,1]
  v_pk_fma_f32 v[102:103], v[202:203], v[226:227], v[102:103] op_sel:[0,1,0] op_sel_hi:[1,1,1]
  v_pk_fma_f32 v[116:117], v[204:205], v[226:227], v[116:117] op_sel:[0,1,0] op_sel_hi:[1,1,1]
  v_pk_fma_f32 v[118:119], v[206:207], v[226:227], v[118:119] op_sel:[0,1,0] op_sel_hi:[1,1,1]
  v_pk_fma_f32 v[8:9], v[176:177], v[228:229], v[8:9] op_sel:[0,1,0] op_sel_hi:[1,1,1]
  s_mov_b32 s64, 16384
  s_add_u32 m0, s61, 33792
  s_nop 0
  buffer_load_dwordx4 v243, s[36:39], s64 offen offset:0 lds
  v_pk_fma_f32 v[10:11], v[178:179], v[228:229], v[10:11] op_sel:[0,1,0] op_sel_hi:[1,1,1]
  v_pk_fma_f32 v[24:25], v[180:181], v[228:229], v[24:25] op_sel:[0,1,0] op_sel_hi:[1,1,1]
  v_pk_fma_f32 v[26:27], v[182:183], v[228:229], v[26:27] op_sel:[0,1,0] op_sel_hi:[1,1,1]
  v_pk_fma_f32 v[40:41], v[184:185], v[228:229], v[40:41] op_sel:[0,1,0] op_sel_hi:[1,1,1]
  v_pk_fma_f32 v[42:43], v[186:187], v[228:229], v[42:43] op_sel:[0,1,0] op_sel_hi:[1,1,1]
  v_pk_fma_f32 v[56:57], v[188:189], v[228:229], v[56:57] op_sel:[0,1,0] op_sel_hi:[1,1,1]
  v_pk_fma_f32 v[58:59], v[190:191], v[228:229], v[58:59] op_sel:[0,1,0] op_sel_hi:[1,1,1]
  v_pk_fma_f32 v[72:73], v[192:193], v[228:229], v[72:73] op_sel:[0,1,0] op_sel_hi:[1,1,1]
  v_pk_fma_f32 v[74:75], v[194:195], v[228:229], v[74:75] op_sel:[0,1,0] op_sel_hi:[1,1,1]
  v_pk_fma_f32 v[88:89], v[196:197], v[228:229], v[88:89] op_sel:[0,1,0] op_sel_hi:[1,1,1]
  v_pk_fma_f32 v[90:91], v[198:199], v[228:229], v[90:91] op_sel:[0,1,0] op_sel_hi:[1,1,1]
  buffer_load_dwordx4 v243, s[36:39], s64 offen offset:1024 lds
  v_pk_fma_f32 v[104:105], v[200:201], v[228:229], v[104:105] op_sel:[0,1,0] op_sel_hi:[1,1,1]
  v_pk_fma_f32 v[106:107], v[202:203], v[228:229], v[106:107] op_sel:[0,1,0] op_sel_hi:[1,1,1]
  v_pk_fma_f32 v[120:121], v[204:205], v[228:229], v[120:121] op_sel:[0,1,0] op_sel_hi:[1,1,1]
  v_pk_fma_f32 v[122:123], v[206:207], v[228:229], v[122:123] op_sel:[0,1,0] op_sel_hi:[1,1,1]
  v_pk_fma_f32 v[12:13], v[176:177], v[230:231], v[12:13] op_sel:[0,1,0] op_sel_hi:[1,1,1]
  v_pk_fma_f32 v[14:15], v[178:179], v[230:231], v[14:15] op_sel:[0,1,0] op_sel_hi:[1,1,1]
  v_pk_fma_f32 v[28:29], v[180:181], v[230:231], v[28:29] op_sel:[0,1,0] op_sel_hi:[1,1,1]
  v_pk_fma_f32 v[30:31], v[182:183], v[230:231], v[30:31] op_sel:[0,1,0] op_sel_hi:[1,1,1]
  v_pk_fma_f32 v[44:45], v[184:185], v[230:231], v[44:45] op_sel:[0,1,0] op_sel_hi:[1,1,1]
  v_pk_fma_f32 v[46:47], v[186:187], v[230:231], v[46:47] op_sel:[0,1,0] op_sel_hi:[1,1,1]
  v_pk_fma_f32 v[60:61], v[188:189], v[230:231], v[60:61] op_sel:[0,1,0] op_sel_hi:[1,1,1]
  s_add_u32 m0, s61, 42240
  s_nop 0
  buffer_load_dwordx4 v244, s[36:39], s64 offen offset:0 lds
  v_pk_fma_f32 v[62:63], v[190:191], v[230:231], v[62:63] op_sel:[0,1,0] op_sel_hi:[1,1,1]
  v_pk_fma_f32 v[76:77], v[192:193], v[230:231], v[76:77] op_sel:[0,1,0] op_sel_hi:[1,1,1]
  v_pk_fma_f32 v[78:79], v[194:195], v[230:231], v[78:79] op_sel:[0,1,0] op_sel_hi:[1,1,1]
  v_pk_fma_f32 v[92:93], v[196:197], v[230:231], v[92:93] op_sel:[0,1,0] op_sel_hi:[1,1,1]
  v_pk_fma_f32 v[94:95], v[198:199], v[230:231], v[94:95] op_sel:[0,1,0] op_sel_hi:[1,1,1]
  v_pk_fma_f32 v[108:109], v[200:201], v[230:231], v[108:109] op_sel:[0,1,0] op_sel_hi:[1,1,1]
  v_pk_fma_f32 v[110:111], v[202:203], v[230:231], v[110:111] op_sel:[0,1,0] op_sel_hi:[1,1,1]
  v_pk_fma_f32 v[124:125], v[204:205], v[230:231], v[124:125] op_sel:[0,1,0] op_sel_hi:[1,1,1]
  v_pk_fma_f32 v[126:127], v[206:207], v[230:231], v[126:127] op_sel:[0,1,0] op_sel_hi:[1,1,1]
  v_pk_mul_f32 v[0:1], v[0:1], v[224:225] op_sel:[0,0] op_sel_hi:[1,0]
  v_pk_mul_f32 v[2:3], v[2:3], v[224:225] op_sel:[0,0] op_sel_hi:[1,0]
  buffer_load_dwordx4 v244, s[36:39], s64 offen offset:1024 lds
  v_pk_mul_f32 v[16:17], v[16:17], v[224:225] op_sel:[0,0] op_sel_hi:[1,0]
  v_pk_mul_f32 v[18:19], v[18:19], v[224:225] op_sel:[0,0] op_sel_hi:[1,0]
  v_pk_mul_f32 v[32:33], v[32:33], v[224:225] op_sel:[0,0] op_sel_hi:[1,0]
  v_pk_mul_f32 v[34:35], v[34:35], v[224:225] op_sel:[0,0] op_sel_hi:[1,0]
  v_pk_mul_f32 v[48:49], v[48:49], v[224:225] op_sel:[0,0] op_sel_hi:[1,0]
  v_pk_mul_f32 v[50:51], v[50:51], v[224:225] op_sel:[0,0] op_sel_hi:[1,0]
  v_pk_mul_f32 v[64:65], v[64:65], v[224:225] op_sel:[0,0] op_sel_hi:[1,0]
  v_pk_mul_f32 v[66:67], v[66:67], v[224:225] op_sel:[0,0] op_sel_hi:[1,0]
  v_pk_mul_f32 v[80:81], v[80:81], v[224:225] op_sel:[0,0] op_sel_hi:[1,0]
  v_pk_mul_f32 v[82:83], v[82:83], v[224:225] op_sel:[0,0] op_sel_hi:[1,0]
  v_pk_mul_f32 v[96:97], v[96:97], v[224:225] op_sel:[0,0] op_sel_hi:[1,0]
  s_add_u32 m0, s61, 59136
  s_nop 0
  buffer_load_dwordx4 v245, s[40:43], s64 offen offset:0 lds
  v_pk_mul_f32 v[98:99], v[98:99], v[224:225] op_sel:[0,0] op_sel_hi:[1,0]
  v_pk_mul_f32 v[112:113], v[112:113], v[224:225] op_sel:[0,0] op_sel_hi:[1,0]
  v_pk_mul_f32 v[114:115], v[114:115], v[224:225] op_sel:[0,0] op_sel_hi:[1,0]
  v_cvt_pk_bf16_f32 v128, v0, v1
  v_cvt_pk_bf16_f32 v129, v2, v3
  v_cvt_pk_bf16_f32 v130, v16, v17
  v_cvt_pk_bf16_f32 v131, v18, v19
  v_cvt_pk_bf16_f32 v132, v32, v33
  v_cvt_pk_bf16_f32 v133, v34, v35
  v_cvt_pk_bf16_f32 v134, v48, v49
  v_cvt_pk_bf16_f32 v135, v50, v51
  s_add_u32 m0, s61, 59936
  s_nop 0
  buffer_load_dwordx4 v245, s[40:43], s64 offen offset:256 lds
  v_cvt_pk_bf16_f32 v136, v64, v65
  v_cvt_pk_bf16_f32 v137, v66, v67
  v_cvt_pk_bf16_f32 v138, v80, v81
  v_cvt_pk_bf16_f32 v139, v82, v83
  v_cvt_pk_bf16_f32 v140, v96, v97
  v_cvt_pk_bf16_f32 v141, v98, v99
  v_cvt_pk_bf16_f32 v142, v112, v113
  v_cvt_pk_bf16_f32 v143, v114, v115
  v_pk_mul_f32 v[4:5], v[4:5], v[226:227] op_sel:[0,0] op_sel_hi:[1,0]
  v_pk_mul_f32 v[6:7], v[6:7], v[226:227] op_sel:[0,0] op_sel_hi:[1,0]
  v_pk_mul_f32 v[20:21], v[20:21], v[226:227] op_sel:[0,0] op_sel_hi:[1,0]
  s_add_u32 m0, s61, 50688
  s_nop 0
  buffer_load_dwordx4 v246, s[40:43], s64 offen offset:0 lds
  v_pk_mul_f32 v[22:23], v[22:23], v[226:227] op_sel:[0,0] op_sel_hi:[1,0]
  v_pk_mul_f32 v[36:37], v[36:37], v[226:227] op_sel:[0,0] op_sel_hi:[1,0]
  v_pk_mul_f32 v[38:39], v[38:39], v[226:227] op_sel:[0,0] op_sel_hi:[1,0]
  v_pk_mul_f32 v[52:53], v[52:53], v[226:227] op_sel:[0,0] op_sel_hi:[1,0]
  v_pk_mul_f32 v[54:55], v[54:55], v[226:227] op_sel:[0,0] op_sel_hi:[1,0]
  v_pk_mul_f32 v[68:69], v[68:69], v[226:227] op_sel:[0,0] op_sel_hi:[1,0]
  v_pk_mul_f32 v[70:71], v[70:71], v[226:227] op_sel:[0,0] op_sel_hi:[1,0]
  v_pk_mul_f32 v[84:85], v[84:85], v[226:227] op_sel:[0,0] op_sel_hi:[1,0]
  v_pk_mul_f32 v[86:87], v[86:87], v[226:227] op_sel:[0,0] op_sel_hi:[1,0]
  v_pk_mul_f32 v[100:101], v[100:101], v[226:227] op_sel:[0,0] op_sel_hi:[1,0]
  v_pk_mul_f32 v[102:103], v[102:103], v[226:227] op_sel:[0,0] op_sel_hi:[1,0]
  s_add_u32 m0, s61, 51488
  s_nop 0
  buffer_load_dwordx4 v246, s[40:43], s64 offen offset:256 lds
  v_pk_mul_f32 v[116:117], v[116:117], v[226:227] op_sel:[0,0] op_sel_hi:[1,0]
  v_pk_mul_f32 v[118:119], v[118:119], v[226:227] op_sel:[0,0] op_sel_hi:[1,0]
  v_cvt_pk_bf16_f32 v144, v4, v5
  v_cvt_pk_bf16_f32 v145, v6, v7
  v_cvt_pk_bf16_f32 v146, v20, v21
  v_cvt_pk_bf16_f32 v147, v22, v23
  v_cvt_pk_bf16_f32 v148, v36, v37
  v_cvt_pk_bf16_f32 v149, v38, v39
  v_cvt_pk_bf16_f32 v150, v52, v53
  v_cvt_pk_bf16_f32 v151, v54, v55
  v_cvt_pk_bf16_f32 v152, v68, v69
  s_mov_b32 s64, 32768
  s_add_u32 m0, s61, 67584
  s_nop 0
  buffer_load_dwordx4 v243, s[36:39], s64 offen offset:0 lds
  v_cvt_pk_bf16_f32 v153, v70, v71
  v_cvt_pk_bf16_f32 v154, v84, v85
  v_cvt_pk_bf16_f32 v155, v86, v87
  v_cvt_pk_bf16_f32 v156, v100, v101
  v_cvt_pk_bf16_f32 v157, v102, v103
  v_cvt_pk_bf16_f32 v158, v116, v117
  v_cvt_pk_bf16_f32 v159, v118, v119
  v_pk_mul_f32 v[8:9], v[8:9], v[228:229] op_sel:[0,0] op_sel_hi:[1,0]
  v_pk_mul_f32 v[10:11], v[10:11], v[228:229] op_sel:[0,0] op_sel_hi:[1,0]
  v_pk_mul_f32 v[24:25], v[24:25], v[228:229] op_sel:[0,0] op_sel_hi:[1,0]
  v_pk_mul_f32 v[26:27], v[26:27], v[228:229] op_sel:[0,0] op_sel_hi:[1,0]
  buffer_load_dwordx4 v243, s[36:39], s64 offen offset:1024 lds
  v_pk_mul_f32 v[40:41], v[40:41], v[228:229] op_sel:[0,0] op_sel_hi:[1,0]
  v_pk_mul_f32 v[42:43], v[42:43], v[228:229] op_sel:[0,0] op_sel_hi:[1,0]
  v_pk_mul_f32 v[56:57], v[56:57], v[228:229] op_sel:[0,0] op_sel_hi:[1,0]
  v_pk_mul_f32 v[58:59], v[58:59], v[228:229] op_sel:[0,0] op_sel_hi:[1,0]
  v_pk_mul_f32 v[72:73], v[72:73], v[228:229] op_sel:[0,0] op_sel_hi:[1,0]
  v_pk_mul_f32 v[74:75], v[74:75], v[228:229] op_sel:[0,0] op_sel_hi:[1,0]
  v_pk_mul_f32 v[88:89], v[88:89], v[228:229] op_sel:[0,0] op_sel_hi:[1,0]
  v_pk_mul_f32 v[90:91], v[90:91], v[228:229] op_sel:[0,0] op_sel_hi:[1,0]
  v_pk_mul_f32 v[104:105], v[104:105], v[228:229] op_sel:[0,0] op_sel_hi:[1,0]
  v_pk_mul_f32 v[106:107], v[106:107], v[228:229] op_sel:[0,0] op_sel_hi:[1,0]
  v_pk_mul_f32 v[120:121], v[120:121], v[228:229] op_sel:[0,0] op_sel_hi:[1,0]
  s_add_u32 m0, s61, 76032
  s_nop 0
  buffer_load_dwordx4 v244, s[36:39], s64 offen offset:0 lds
  v_pk_mul_f32 v[122:123], v[122:123], v[228:229] op_sel:[0,0] op_sel_hi:[1,0]
  v_cvt_pk_bf16_f32 v160, v8, v9
  v_cvt_pk_bf16_f32 v161, v10, v11
  v_cvt_pk_bf16_f32 v162, v24, v25
  v_cvt_pk_bf16_f32 v163, v26, v27
  v_cvt_pk_bf16_f32 v164, v40, v41
  v_cvt_pk_bf16_f32 v165, v42, v43
  v_cvt_pk_bf16_f32 v166, v56, v57
  v_cvt_pk_bf16_f32 v167, v58, v59
  v_cvt_pk_bf16_f32 v168, v72, v73
  v_cvt_pk_bf16_f32 v169, v74, v75
  buffer_load_dwordx4 v244, s[36:39], s64 offen offset:1024 lds
  v_cvt_pk_bf16_f32 v170, v88, v89
  v_cvt_pk_bf16_f32 v171, v90, v91
  v_cvt_pk_bf16_f32 v172, v104, v105
  v_cvt_pk_bf16_f32 v173, v106, v107
  v_cvt_pk_bf16_f32 v174, v120, v121
  v_cvt_pk_bf16_f32 v175, v122, v123
  v_pk_mul_f32 v[12:13], v[12:13], v[230:231] op_sel:[0,0] op_sel_hi:[1,0]
  v_pk_mul_f32 v[14:15], v[14:15], v[230:231] op_sel:[0,0] op_sel_hi:[1,0]
  v_pk_mul_f32 v[28:29], v[28:29], v[230:231] op_sel:[0,0] op_sel_hi:[1,0]
  v_pk_mul_f32 v[30:31], v[30:31], v[230:231] op_sel:[0,0] op_sel_hi:[1,0]
  v_pk_mul_f32 v[44:45], v[44:45], v[230:231] op_sel:[0,0] op_sel_hi:[1,0]
  s_add_u32 m0, s61, 92928
  s_nop 0
  buffer_load_dwordx4 v245, s[40:43], s64 offen offset:0 lds
  v_pk_mul_f32 v[46:47], v[46:47], v[230:231] op_sel:[0,0] op_sel_hi:[1,0]
  v_pk_mul_f32 v[60:61], v[60:61], v[230:231] op_sel:[0,0] op_sel_hi:[1,0]
  v_pk_mul_f32 v[62:63], v[62:63], v[230:231] op_sel:[0,0] op_sel_hi:[1,0]
  v_pk_mul_f32 v[76:77], v[76:77], v[230:231] op_sel:[0,0] op_sel_hi:[1,0]
  v_pk_mul_f32 v[78:79], v[78:79], v[230:231] op_sel:[0,0] op_sel_hi:[1,0]
  v_pk_mul_f32 v[92:93], v[92:93], v[230:231] op_sel:[0,0] op_sel_hi:[1,0]
  v_pk_mul_f32 v[94:95], v[94:95], v[230:231] op_sel:[0,0] op_sel_hi:[1,0]
  v_pk_mul_f32 v[108:109], v[108:109], v[230:231] op_sel:[0,0] op_sel_hi:[1,0]
  v_pk_mul_f32 v[110:111], v[110:111], v[230:231] op_sel:[0,0] op_sel_hi:[1,0]
  v_pk_mul_f32 v[124:125], v[124:125], v[230:231] op_sel:[0,0] op_sel_hi:[1,0]
  v_pk_mul_f32 v[126:127], v[126:127], v[230:231] op_sel:[0,0] op_sel_hi:[1,0]
  s_add_u32 m0, s61, 93728
  s_nop 0
  buffer_load_dwordx4 v245, s[40:43], s64 offen offset:256 lds
  v_cvt_pk_bf16_f32 v176, v12, v13
  v_cvt_pk_bf16_f32 v177, v14, v15
  v_cvt_pk_bf16_f32 v178, v28, v29
  v_cvt_pk_bf16_f32 v179, v30, v31
  v_cvt_pk_bf16_f32 v180, v44, v45
  v_cvt_pk_bf16_f32 v181, v46, v47
  v_cvt_pk_bf16_f32 v182, v60, v61
  v_cvt_pk_bf16_f32 v183, v62, v63
  v_cvt_pk_bf16_f32 v184, v76, v77
  v_cvt_pk_bf16_f32 v185, v78, v79
  v_cvt_pk_bf16_f32 v186, v92, v93
  s_add_u32 m0, s61, 84480
  s_nop 0
  buffer_load_dwordx4 v246, s[40:43], s64 offen offset:0 lds
  v_cvt_pk_bf16_f32 v187, v94, v95
  v_cvt_pk_bf16_f32 v188, v108, v109
  v_cvt_pk_bf16_f32 v189, v110, v111
  v_cvt_pk_bf16_f32 v190, v124, v125
  v_cvt_pk_bf16_f32 v191, v126, v127
  ds_read_b128 v[96:99], v215 offset:128
  ds_read_b128 v[100:103], v215 offset:192
  ds_read_b128 v[104:107], v215 offset:8320
  ds_read_b128 v[108:111], v215 offset:8384
  ds_read_b128 v[112:115], v215 offset:16512
  ds_read_b128 v[116:119], v215 offset:16576
  ds_read_b128 v[120:123], v215 offset:24704
  ds_read_b128 v[124:127], v215 offset:24768
  ds_write_b32 v254, v232
  s_lshl_b32 s53, s86, 11
  v_add_u32 v30, s53, v241
  s_sub_u32 s53, 2048, s53
  v_add_u32 v31, s53, v241
  s_lshr_b32 s53, s49, 1
  s_mul_i32 s53, s53, 3
  s_lshl_b32 s54, s86, 1
  s_add_u32 s53, s53, s54
  s_lshl_b32 s54, s53, 12
  s_add_u32 s54, s54, s65
  s_add_u32 s54, s54, 524288
  s_cmp_lt_u32 s53, 43
  s_cselect_b32 s77, s54, 0x7f000000
  v_accvgpr_read_b32 v32, a128
  v_accvgpr_read_b32 v33, a129
  v_accvgpr_read_b32 v34, a130
  v_accvgpr_read_b32 v35, a131
  v_accvgpr_read_b32 v40, a144
  v_accvgpr_read_b32 v41, a145
  s_add_u32 m0, s61, 85280
  s_nop 0
  buffer_load_dwordx4 v246, s[40:43], s64 offen offset:256 lds
  v_accvgpr_read_b32 v42, a146
  v_accvgpr_read_b32 v43, a147
  v_accvgpr_read_b32 v36, a160
  v_accvgpr_read_b32 v37, a161
  v_accvgpr_read_b32 v38, a162
  v_accvgpr_read_b32 v39, a163
  v_accvgpr_read_b32 v44, a176
  v_accvgpr_read_b32 v45, a177
  v_accvgpr_read_b32 v46, a178
  v_accvgpr_read_b32 v47, a179
  s_waitcnt lgkmcnt(0)
  v_pk_fma_f32 v[32:33], v[96:97], v[216:217], v[32:33] op_sel:[0,1,0] op_sel_hi:[1,1,1]
  s_mov_b32 s64, 49152
  s_add_u32 m0, s61, 101376
  s_nop 0
  buffer_load_dwordx4 v243, s[36:39], s64 offen offset:0 lds
  v_pk_fma_f32 v[34:35], v[98:99], v[216:217], v[34:35] op_sel:[0,1,0] op_sel_hi:[1,1,1]
  v_pk_fma_f32 v[40:41], v[100:101], v[216:217], v[40:41] op_sel:[0,1,0] op_sel_hi:[1,1,1]
  v_pk_fma_f32 v[42:43], v[102:103], v[216:217], v[42:43] op_sel:[0,1,0] op_sel_hi:[1,1,1]
  v_pk_fma_f32 v[36:37], v[104:105], v[216:217], v[36:37] op_sel:[0,1,0] op_sel_hi:[1,1,1]
  v_pk_fma_f32 v[38:39], v[106:107], v[216:217], v[38:39] op_sel:[0,1,0] op_sel_hi:[1,1,1]
  v_pk_fma_f32 v[44:45], v[108:109], v[216:217], v[44:45] op_sel:[0,1,0] op_sel_hi:[1,1,1]
  v_pk_fma_f32 v[46:47], v[110:111], v[216:217], v[46:47] op_sel:[0,1,0] op_sel_hi:[1,1,1]
  v_pk_mul_f32 v[32:33], v[32:33], v[40:41]
  v_pk_mul_f32 v[34:35], v[34:35], v[42:43]
  v_pk_mul_f32 v[36:37], v[36:37], v[44:45]
  v_pk_mul_f32 v[38:39], v[38:39], v[46:47]
  buffer_load_dwordx4 v243, s[36:39], s64 offen offset:1024 lds
  v_pk_mul_f32 v[32:33], v[32:33], v[216:217] op_sel:[0,0] op_sel_hi:[1,0]
  v_pk_mul_f32 v[34:35], v[34:35], v[216:217] op_sel:[0,0] op_sel_hi:[1,0]
  v_pk_mul_f32 v[36:37], v[36:37], v[216:217] op_sel:[0,0] op_sel_hi:[1,0]
  v_pk_mul_f32 v[38:39], v[38:39], v[216:217] op_sel:[0,0] op_sel_hi:[1,0]
  v_cvt_pk_bf16_f32 v64, v32, v33
  v_cvt_pk_bf16_f32 v65, v34, v35
  v_cvt_pk_bf16_f32 v66, v36, v37
  v_cvt_pk_bf16_f32 v67, v38, v39
  v_accvgpr_read_b32 v48, a132
  v_accvgpr_read_b32 v49, a133
  v_accvgpr_read_b32 v50, a134
  s_add_u32 m0, s61, 109824
  s_nop 0
  buffer_load_dwordx4 v244, s[36:39], s64 offen offset:0 lds
  v_accvgpr_read_b32 v51, a135
  v_accvgpr_read_b32 v56, a148
  v_accvgpr_read_b32 v57, a149
  v_accvgpr_read_b32 v58, a150
  v_accvgpr_read_b32 v59, a151
  v_accvgpr_read_b32 v52, a164
  v_accvgpr_read_b32 v53, a165
  v_accvgpr_read_b32 v54, a166
  v_accvgpr_read_b32 v55, a167
  v_accvgpr_read_b32 v60, a180
  v_accvgpr_read_b32 v61, a181
  buffer_load_dwordx4 v244, s[36:39], s64 offen offset:1024 lds
  v_accvgpr_read_b32 v62, a182
  v_accvgpr_read_b32 v63, a183
  v_pk_fma_f32 v[48:49], v[96:97], v[218:219], v[48:49] op_sel:[0,1,0] op_sel_hi:[1,1,1]
  v_pk_fma_f32 v[50:51], v[98:99], v[218:219], v[50:51] op_sel:[0,1,0] op_sel_hi:[1,1,1]
  v_pk_fma_f32 v[56:57], v[100:101], v[218:219], v[56:57] op_sel:[0,1,0] op_sel_hi:[1,1,1]
  v_pk_fma_f32 v[58:59], v[102:103], v[218:219], v[58:59] op_sel:[0,1,0] op_sel_hi:[1,1,1]
  v_pk_fma_f32 v[52:53], v[104:105], v[218:219], v[52:53] op_sel:[0,1,0] op_sel_hi:[1,1,1]
  v_pk_fma_f32 v[54:55], v[106:107], v[218:219], v[54:55] op_sel:[0,1,0] op_sel_hi:[1,1,1]
  v_pk_fma_f32 v[60:61], v[108:109], v[218:219], v[60:61] op_sel:[0,1,0] op_sel_hi:[1,1,1]
  v_pk_fma_f32 v[62:63], v[110:111], v[218:219], v[62:63] op_sel:[0,1,0] op_sel_hi:[1,1,1]
  v_pk_mul_f32 v[48:49], v[48:49], v[56:57]
  s_add_u32 m0, s61, 126720
  s_nop 0
  buffer_load_dwordx4 v245, s[40:43], s64 offen offset:0 lds
  v_pk_mul_f32 v[50:51], v[50:51], v[58:59]
  v_pk_mul_f32 v[52:53], v[52:53], v[60:61]
  v_pk_mul_f32 v[54:55], v[54:55], v[62:63]
  v_pk_mul_f32 v[48:49], v[48:49], v[218:219] op_sel:[0,0] op_sel_hi:[1,0]
  v_pk_mul_f32 v[50:51], v[50:51], v[218:219] op_sel:[0,0] op_sel_hi:[1,0]
  v_pk_mul_f32 v[52:53], v[52:53], v[218:219] op_sel:[0,0] op_sel_hi:[1,0]
  v_pk_mul_f32 v[54:55], v[54:55], v[218:219] op_sel:[0,0] op_sel_hi:[1,0]
  v_cvt_pk_bf16_f32 v68, v48, v49
  v_cvt_pk_bf16_f32 v69, v50, v51
  v_cvt_pk_bf16_f32 v70, v52, v53
  v_cvt_pk_bf16_f32 v71, v54, v55
  s_add_u32 m0, s61, 127520
  s_nop 0
  buffer_load_dwordx4 v245, s[40:43], s64 offen offset:256 lds
  v_accvgpr_read_b32 v32, a136
  v_accvgpr_read_b32 v33, a137
  v_accvgpr_read_b32 v34, a138
  v_accvgpr_read_b32 v35, a139
  v_accvgpr_read_b32 v40, a152
  v_accvgpr_read_b32 v41, a153
  v_accvgpr_read_b32 v42, a154
  v_accvgpr_read_b32 v43, a155
  v_accvgpr_read_b32 v36, a168
  v_accvgpr_read_b32 v37, a169
  v_accvgpr_read_b32 v38, a170
  s_add_u32 m0, s61, 118272
  s_nop 0
  buffer_load_dwordx4 v246, s[40:43], s64 offen offset:0 lds
  v_accvgpr_read_b32 v39, a171
  v_accvgpr_read_b32 v44, a184
  v_accvgpr_read_b32 v45, a185
  v_accvgpr_read_b32 v46, a186
  v_accvgpr_read_b32 v47, a187
  v_pk_fma_f32 v[32:33], v[96:97], v[220:221], v[32:33] op_sel:[0,1,0] op_sel_hi:[1,1,1]
  v_pk_fma_f32 v[34:35], v[98:99], v[220:221], v[34:35] op_sel:[0,1,0] op_sel_hi:[1,1,1]
  v_pk_fma_f32 v[40:41], v[100:101], v[220:221], v[40:41] op_sel:[0,1,0] op_sel_hi:[1,1,1]
  v_pk_fma_f32 v[42:43], v[102:103], v[220:221], v[42:43] op_sel:[0,1,0] op_sel_hi:[1,1,1]
  v_pk_fma_f32 v[36:37], v[104:105], v[220:221], v[36:37] op_sel:[0,1,0] op_sel_hi:[1,1,1]
  v_pk_fma_f32 v[38:39], v[106:107], v[220:221], v[38:39] op_sel:[0,1,0] op_sel_hi:[1,1,1]
  s_add_u32 m0, s61, 119072
  s_nop 0
  buffer_load_dwordx4 v246, s[40:43], s64 offen offset:256 lds
  v_pk_fma_f32 v[44:45], v[108:109], v[220:221], v[44:45] op_sel:[0,1,0] op_sel_hi:[1,1,1]
  v_pk_fma_f32 v[46:47], v[110:111], v[220:221], v[46:47] op_sel:[0,1,0] op_sel_hi:[1,1,1]
  v_pk_mul_f32 v[32:33], v[32:33], v[40:41]
  v_pk_mul_f32 v[34:35], v[34:35], v[42:43]
  v_pk_mul_f32 v[36:37], v[36:37], v[44:45]
  v_pk_mul_f32 v[38:39], v[38:39], v[46:47]
  v_pk_mul_f32 v[32:33], v[32:33], v[220:221] op_sel:[0,0] op_sel_hi:[1,0]
  v_pk_mul_f32 v[34:35], v[34:35], v[220:221] op_sel:[0,0] op_sel_hi:[1,0]
  v_pk_mul_f32 v[36:37], v[36:37], v[220:221] op_sel:[0,0] op_sel_hi:[1,0]
  v_pk_mul_f32 v[38:39], v[38:39], v[220:221] op_sel:[0,0] op_sel_hi:[1,0]
  v_cvt_pk_bf16_f32 v72, v32, v33
  v_cvt_pk_bf16_f32 v73, v34, v35
  v_cvt_pk_bf16_f32 v74, v36, v37
  v_cvt_pk_bf16_f32 v75, v38, v39
  buffer_store_dwordx4 v[64:67], v30, s[44:47], s77 offen offset:0 sc1
  buffer_store_dwordx4 v[68:71], v30, s[44:47], s77 offen offset:1024 sc1
  buffer_store_dwordx4 v[72:75], v31, s[44:47], s77 offen offset:0 sc1
  v_accvgpr_read_b32 v48, a140
  v_accvgpr_read_b32 v49, a141
  v_accvgpr_read_b32 v50, a142
  v_accvgpr_read_b32 v51, a143
  v_accvgpr_read_b32 v56, a156
  v_accvgpr_read_b32 v57, a157
  v_accvgpr_read_b32 v58, a158
  v_accvgpr_read_b32 v59, a159
  v_accvgpr_read_b32 v52, a172
  v_accvgpr_read_b32 v53, a173
  v_accvgpr_read_b32 v54, a174
  v_accvgpr_read_b32 v55, a175
  v_accvgpr_read_b32 v60, a188
  v_accvgpr_read_b32 v61, a189
  v_accvgpr_read_b32 v62, a190
  v_accvgpr_read_b32 v63, a191
  v_pk_fma_f32 v[48:49], v[96:97], v[222:223], v[48:49] op_sel:[0,1,0] op_sel_hi:[1,1,1]
  v_pk_fma_f32 v[50:51], v[98:99], v[222:223], v[50:51] op_sel:[0,1,0] op_sel_hi:[1,1,1]
  v_pk_fma_f32 v[56:57], v[100:101], v[222:223], v[56:57] op_sel:[0,1,0] op_sel_hi:[1,1,1]
  v_pk_fma_f32 v[58:59], v[102:103], v[222:223], v[58:59] op_sel:[0,1,0] op_sel_hi:[1,1,1]
  v_pk_fma_f32 v[52:53], v[104:105], v[222:223], v[52:53] op_sel:[0,1,0] op_sel_hi:[1,1,1]
  v_pk_fma_f32 v[54:55], v[106:107], v[222:223], v[54:55] op_sel:[0,1,0] op_sel_hi:[1,1,1]
  v_pk_fma_f32 v[60:61], v[108:109], v[222:223], v[60:61] op_sel:[0,1,0] op_sel_hi:[1,1,1]
  v_pk_fma_f32 v[62:63], v[110:111], v[222:223], v[62:63] op_sel:[0,1,0] op_sel_hi:[1,1,1]
  v_pk_mul_f32 v[48:49], v[48:49], v[56:57]
  v_pk_mul_f32 v[50:51], v[50:51], v[58:59]
  v_pk_mul_f32 v[52:53], v[52:53], v[60:61]
  v_pk_mul_f32 v[54:55], v[54:55], v[62:63]
  v_pk_mul_f32 v[48:49], v[48:49], v[222:223] op_sel:[0,0] op_sel_hi:[1,0]
  v_pk_mul_f32 v[50:51], v[50:51], v[222:223] op_sel:[0,0] op_sel_hi:[1,0]
  v_pk_mul_f32 v[52:53], v[52:53], v[222:223] op_sel:[0,0] op_sel_hi:[1,0]
  v_pk_mul_f32 v[54:55], v[54:55], v[222:223] op_sel:[0,0] op_sel_hi:[1,0]
  v_cvt_pk_bf16_f32 v76, v48, v49
  v_cvt_pk_bf16_f32 v77, v50, v51
  v_cvt_pk_bf16_f32 v78, v52, v53
  v_cvt_pk_bf16_f32 v79, v54, v55
  buffer_store_dwordx4 v[76:79], v31, s[44:47], s77 offen offset:1024 sc1
  s_lshr_b32 s53, s49, 1
  s_mul_i32 s53, s53, 3
  s_add_u32 s53, s53, 1
  s_lshl_b32 s54, s53, 12
  s_add_u32 s54, s54, s65
  s_add_u32 s54, s54, 524288
  s_cmp_lt_u32 s53, 43
  s_cselect_b32 s77, s54, 0x7f000000
  v_accvgpr_read_b32 v32, a192
  v_accvgpr_read_b32 v33, a193
  v_accvgpr_read_b32 v34, a194
  v_accvgpr_read_b32 v35, a195
  v_accvgpr_read_b32 v40, a200
  v_accvgpr_read_b32 v41, a201
  v_accvgpr_read_b32 v42, a202
  v_accvgpr_read_b32 v43, a203
  v_accvgpr_read_b32 v36, a208
  v_accvgpr_read_b32 v37, a209
  v_accvgpr_read_b32 v38, a210
  v_accvgpr_read_b32 v39, a211
  v_accvgpr_read_b32 v44, a216
  v_accvgpr_read_b32 v45, a217
  v_accvgpr_read_b32 v46, a218
  v_accvgpr_read_b32 v47, a219
  v_pk_fma_f32 v[32:33], v[112:113], v[216:217], v[32:33] op_sel:[0,1,0] op_sel_hi:[1,1,1]
  v_pk_fma_f32 v[34:35], v[114:115], v[216:217], v[34:35] op_sel:[0,1,0] op_sel_hi:[1,1,1]
  v_pk_fma_f32 v[40:41], v[116:117], v[216:217], v[40:41] op_sel:[0,1,0] op_sel_hi:[1,1,1]
  v_pk_fma_f32 v[42:43], v[118:119], v[216:217], v[42:43] op_sel:[0,1,0] op_sel_hi:[1,1,1]
  v_pk_fma_f32 v[36:37], v[120:121], v[216:217], v[36:37] op_sel:[0,1,0] op_sel_hi:[1,1,1]
  v_pk_fma_f32 v[38:39], v[122:123], v[216:217], v[38:39] op_sel:[0,1,0] op_sel_hi:[1,1,1]
  v_pk_fma_f32 v[44:45], v[124:125], v[216:217], v[44:45] op_sel:[0,1,0] op_sel_hi:[1,1,1]
  v_pk_fma_f32 v[46:47], v[126:127], v[216:217], v[46:47] op_sel:[0,1,0] op_sel_hi:[1,1,1]
  v_pk_mul_f32 v[32:33], v[32:33], v[40:41]
  v_pk_mul_f32 v[34:35], v[34:35], v[42:43]
  v_pk_mul_f32 v[36:37], v[36:37], v[44:45]
  v_pk_mul_f32 v[38:39], v[38:39], v[46:47]
  v_pk_mul_f32 v[32:33], v[32:33], v[216:217] op_sel:[0,0] op_sel_hi:[1,0]
  v_pk_mul_f32 v[34:35], v[34:35], v[216:217] op_sel:[0,0] op_sel_hi:[1,0]
  v_pk_mul_f32 v[36:37], v[36:37], v[216:217] op_sel:[0,0] op_sel_hi:[1,0]
  v_pk_mul_f32 v[38:39], v[38:39], v[216:217] op_sel:[0,0] op_sel_hi:[1,0]
  v_cvt_pk_bf16_f32 v64, v32, v33
  v_cvt_pk_bf16_f32 v65, v34, v35
  v_cvt_pk_bf16_f32 v66, v36, v37
  v_cvt_pk_bf16_f32 v67, v38, v39
  buffer_store_dwordx4 v[64:67], v30, s[44:47], s77 offen offset:0 sc1
  v_accvgpr_read_b32 v48, a196
  v_accvgpr_read_b32 v49, a197
  v_accvgpr_read_b32 v50, a198
  v_accvgpr_read_b32 v51, a199
  v_accvgpr_read_b32 v56, a204
  v_accvgpr_read_b32 v57, a205
  v_accvgpr_read_b32 v58, a206
  v_accvgpr_read_b32 v59, a207
  v_accvgpr_read_b32 v52, a212
  v_accvgpr_read_b32 v53, a213
  v_accvgpr_read_b32 v54, a214
  v_accvgpr_read_b32 v55, a215
  v_accvgpr_read_b32 v60, a220
  v_accvgpr_read_b32 v61, a221
  v_accvgpr_read_b32 v62, a222
  v_accvgpr_read_b32 v63, a223
  v_pk_fma_f32 v[48:49], v[112:113], v[218:219], v[48:49] op_sel:[0,1,0] op_sel_hi:[1,1,1]
  v_pk_fma_f32 v[50:51], v[114:115], v[218:219], v[50:51] op_sel:[0,1,0] op_sel_hi:[1,1,1]
  v_pk_fma_f32 v[56:57], v[116:117], v[218:219], v[56:57] op_sel:[0,1,0] op_sel_hi:[1,1,1]
  v_pk_fma_f32 v[58:59], v[118:119], v[218:219], v[58:59] op_sel:[0,1,0] op_sel_hi:[1,1,1]
  v_pk_fma_f32 v[52:53], v[120:121], v[218:219], v[52:53] op_sel:[0,1,0] op_sel_hi:[1,1,1]
  v_pk_fma_f32 v[54:55], v[122:123], v[218:219], v[54:55] op_sel:[0,1,0] op_sel_hi:[1,1,1]
  v_pk_fma_f32 v[60:61], v[124:125], v[218:219], v[60:61] op_sel:[0,1,0] op_sel_hi:[1,1,1]
  v_pk_fma_f32 v[62:63], v[126:127], v[218:219], v[62:63] op_sel:[0,1,0] op_sel_hi:[1,1,1]
  v_pk_mul_f32 v[48:49], v[48:49], v[56:57]
  v_pk_mul_f32 v[50:51], v[50:51], v[58:59]
  v_pk_mul_f32 v[52:53], v[52:53], v[60:61]
  v_pk_mul_f32 v[54:55], v[54:55], v[62:63]
  v_pk_mul_f32 v[48:49], v[48:49], v[218:219] op_sel:[0,0] op_sel_hi:[1,0]
  v_pk_mul_f32 v[50:51], v[50:51], v[218:219] op_sel:[0,0] op_sel_hi:[1,0]
  v_pk_mul_f32 v[52:53], v[52:53], v[218:219] op_sel:[0,0] op_sel_hi:[1,0]
  v_pk_mul_f32 v[54:55], v[54:55], v[218:219] op_sel:[0,0] op_sel_hi:[1,0]
  v_cvt_pk_bf16_f32 v68, v48, v49
  v_cvt_pk_bf16_f32 v69, v50, v51
  v_cvt_pk_bf16_f32 v70, v52, v53
  v_cvt_pk_bf16_f32 v71, v54, v55
  buffer_store_dwordx4 v[68:71], v30, s[44:47], s77 offen offset:1024 sc1
  s_bfe_u32 s24, s2, 0x20001
  s_and_b32 s25, s2, 1
  s_lshl_b32 s25, s25, 3
  s_bfe_u32 s26, s2, 0x30003
  s_add_u32 s25, s25, s26
  s_lshr_b32 s26, s2, 6
  s_lshl_b32 s27, s25, 2
  s_add_u32 s27, s27, s26
  s_lshl_b32 s27, s27, 17
  s_add_u32 s27, s27, s55
  s_lshl_b32 s31, s24, 3
  s_lshr_b32 s31, 0x24343239, s31
  s_lshl_b32 s32, s24, 11
  s_add_u32 s32, s32, s27
  s_bfe_u32 s28, s31, 0x20000
  s_lshl_b32 s28, s28, 15
  s_add_u32 s28, s28, s32
  s_bfe_u32 s29, s31, 0x20002
  s_lshl_b32 s29, s29, 15
  s_add_u32 s29, s29, s32
  s_bfe_u32 s30, s31, 0x20004
  s_lshl_b32 s30, s30, 15
  s_add_u32 s30, s30, s32
  v_add_u32 v211, 136192, v241
  v_mov_b32 v255, 0
  v_mov_b32 v210, 137216
  ds_write_b32 v210, v232
  s_mov_b32 s87, 8
  v_mov_b32 v252, v247
  v_mov_b32 v253, v248
  s_waitcnt vmcnt(30)
  s_barrier
  ds_read_b128 a[128:131], v252 offset:0
  ds_read_b128 a[132:135], v252 offset:64
  ds_read_b128 a[136:139], v252 offset:128
  ds_read_b128 a[140:143], v252 offset:192
  ds_read_b128 a[144:147], v252 offset:1024
  ds_read_b128 a[148:151], v252 offset:1088
  ds_read_b128 a[152:155], v252 offset:1152
  ds_read_b128 a[156:159], v252 offset:1216
  ds_read_b128 a[192:195], v252 offset:8448
  ds_read_b128 a[196:199], v252 offset:8512
  ds_read_b128 a[200:203], v252 offset:8576
  ds_read_b128 a[204:207], v252 offset:8640
  ds_read_b128 a[208:211], v252 offset:9472
  ds_read_b128 a[212:215], v252 offset:9536
  s_waitcnt lgkmcnt(6)
  v_mfma_f32_16x16x32_bf16 v[32:35], a[128:131], v[128:131], 0
  ds_read_b128 a[216:219], v252 offset:9600
  v_mfma_f32_16x16x32_bf16 v[32:35], a[132:135], v[132:135], v[32:35]
  ds_read_b128 a[220:223], v252 offset:9664
  v_mfma_f32_16x16x32_bf16 v[32:35], a[136:139], v[136:139], v[32:35]
  ds_read_b64_tr_b16 a[224:225], v253 offset:16896
  v_mfma_f32_16x16x32_bf16 v[32:35], a[140:143], v[140:143], v[32:35]
  ds_read_b64_tr_b16 a[226:227], v253 offset:17152
  v_mfma_f32_16x16x32_bf16 v[36:39], a[144:147], v[128:131], 0
  ds_read_b64_tr_b16 a[228:229], v253 offset:16928
  v_mfma_f32_16x16x32_bf16 v[36:39], a[148:151], v[132:135], v[36:39]
  ds_read_b64_tr_b16 a[230:231], v253 offset:17184
  v_mfma_f32_16x16x32_bf16 v[36:39], a[152:155], v[136:139], v[36:39]
  ds_read_b64_tr_b16 a[232:233], v253 offset:16960
  v_mfma_f32_16x16x32_bf16 v[36:39], a[156:159], v[140:143], v[36:39]
  ds_read_b64_tr_b16 a[234:235], v253 offset:17216
  v_mfma_f32_16x16x32_bf16 v[40:43], a[128:131], v[144:147], 0
  ds_read_b64_tr_b16 a[236:237], v253 offset:16992
  v_mfma_f32_16x16x32_bf16 v[40:43], a[132:135], v[148:151], v[40:43]
  ds_read_b64_tr_b16 a[238:239], v253 offset:17248
  v_mfma_f32_16x16x32_bf16 v[40:43], a[136:139], v[152:155], v[40:43]
  ds_read_b64_tr_b16 a[240:241], v253 offset:17024
  v_mfma_f32_16x16x32_bf16 v[40:43], a[140:143], v[156:159], v[40:43]
  ds_read_b64_tr_b16 a[242:243], v253 offset:17280
  v_mfma_f32_16x16x32_bf16 v[44:47], a[144:147], v[144:147], 0
  ds_read_b64_tr_b16 a[244:245], v253 offset:17056
  v_mfma_f32_16x16x32_bf16 v[44:47], a[148:151], v[148:151], v[44:47]
  ds_read_b64_tr_b16 a[246:247], v253 offset:17312
  v_mfma_f32_16x16x32_bf16 v[44:47], a[152:155], v[152:155], v[44:47]
  ds_read_b64_tr_b16 a[248:249], v253 offset:17088
  v_mfma_f32_16x16x32_bf16 v[44:47], a[156:159], v[156:159], v[44:47]
  ds_read_b64_tr_b16 a[250:251], v253 offset:17344
  v_mfma_f32_16x16x32_bf16 v[48:51], a[128:131], v[160:163], 0
  ds_read_b64_tr_b16 a[252:253], v253 offset:17120
  v_mfma_f32_16x16x32_bf16 v[48:51], a[132:135], v[164:167], v[48:51]
  ds_read_b64_tr_b16 a[254:255], v253 offset:17376
  v_mfma_f32_16x16x32_bf16 v[48:51], a[136:139], v[168:171], v[48:51]
  v_mov_b32 v212, 0
  v_mov_b32 v213, 0
  v_mfma_f32_16x16x32_bf16 v[48:51], a[140:143], v[172:175], v[48:51]
  v_mov_b32 v214, 0
  v_mov_b32 v215, 0
  v_mfma_f32_16x16x32_bf16 v[52:55], a[144:147], v[160:163], 0
  v_mov_b32 v216, 0
  v_mov_b32 v217, 0
  v_mfma_f32_16x16x32_bf16 v[52:55], a[148:151], v[164:167], v[52:55]
  v_mov_b32 v218, 0
  v_mov_b32 v219, 0
  v_mfma_f32_16x16x32_bf16 v[52:55], a[152:155], v[168:171], v[52:55]
  v_mov_b32 v220, 0
  v_mov_b32 v221, 0
  v_mfma_f32_16x16x32_bf16 v[52:55], a[156:159], v[172:175], v[52:55]
  v_mov_b32 v222, 0
  v_mov_b32 v223, 0
  v_mfma_f32_16x16x32_bf16 v[56:59], a[128:131], v[176:179], 0
  v_mov_b32 v224, 0
  v_mov_b32 v225, 0
  v_mfma_f32_16x16x32_bf16 v[56:59], a[132:135], v[180:183], v[56:59]
  v_mov_b32 v226, 0
  v_mov_b32 v227, 0
  v_mfma_f32_16x16x32_bf16 v[56:59], a[136:139], v[184:187], v[56:59]
  v_mfma_f32_16x16x32_bf16 v[56:59], a[140:143], v[188:191], v[56:59]
  v_mfma_f32_16x16x32_bf16 v[60:63], a[144:147], v[176:179], 0
  v_mfma_f32_16x16x32_bf16 v[60:63], a[148:151], v[180:183], v[60:63]
  v_mfma_f32_16x16x32_bf16 v[60:63], a[152:155], v[184:187], v[60:63]
  v_mfma_f32_16x16x32_bf16 v[60:63], a[156:159], v[188:191], v[60:63]
  s_nop 3
  v_max3_f32 v0, v32, v33, v34
  v_max3_f32 v1, v40, v41, v42
  v_max3_f32 v2, v48, v49, v50
  v_max3_f32 v3, v56, v57, v58
  v_max3_f32 v0, v0, v35, v36
  v_max3_f32 v1, v1, v43, v44
  v_max3_f32 v2, v2, v51, v52
  v_max3_f32 v3, v3, v59, v60
  v_max3_f32 v0, v0, v37, v38
  v_max3_f32 v1, v1, v45, v46
  v_max3_f32 v2, v2, v53, v54
  v_max3_f32 v3, v3, v61, v62
  v_max_f32 v0, v0, v39
  v_max_f32 v1, v1, v47
  v_max_f32 v2, v2, v55
  v_max_f32 v3, v3, v63
  v_mov_b32 v4, v0
  v_mov_b32 v5, v1
  v_mov_b32 v6, v2
  v_mov_b32 v7, v3
  s_nop 0
  v_permlane32_swap_b32 v0, v4
  v_permlane32_swap_b32 v1, v5
  v_permlane32_swap_b32 v2, v6
  v_permlane32_swap_b32 v3, v7
  v_max_f32 v0, v0, v4
  v_max_f32 v1, v1, v5
  v_max_f32 v2, v2, v6
  v_max_f32 v3, v3, v7
  v_mov_b32 v4, v0
  v_mov_b32 v5, v1
  v_mov_b32 v6, v2
  v_mov_b32 v7, v3
  s_nop 0
  v_permlane16_swap_b32 v0, v4
  v_permlane16_swap_b32 v1, v5
  v_permlane16_swap_b32 v2, v6
  v_permlane16_swap_b32 v3, v7
  v_max_f32 v0, v0, v4
  v_max_f32 v1, v1, v5
  v_max_f32 v2, v2, v6
  v_max_f32 v3, v3, v7
  v_sub_f32 v32, v32, v0
  v_sub_f32 v33, v33, v0
  v_sub_f32 v34, v34, v0
  v_sub_f32 v35, v35, v0
  v_sub_f32 v36, v36, v0
  v_sub_f32 v37, v37, v0
  v_sub_f32 v38, v38, v0
  v_sub_f32 v39, v39, v0
  v_sub_f32 v40, v40, v1
  v_sub_f32 v41, v41, v1
  v_sub_f32 v42, v42, v1
  v_sub_f32 v43, v43, v1
  v_sub_f32 v44, v44, v1
  v_sub_f32 v45, v45, v1
  v_sub_f32 v46, v46, v1
  v_sub_f32 v47, v47, v1
  v_sub_f32 v48, v48, v2
  v_sub_f32 v49, v49, v2
  v_sub_f32 v50, v50, v2
  v_sub_f32 v51, v51, v2
  v_sub_f32 v52, v52, v2
  v_sub_f32 v53, v53, v2
  v_sub_f32 v54, v54, v2
  v_sub_f32 v55, v55, v2
  v_sub_f32 v56, v56, v3
  v_sub_f32 v57, v57, v3
  v_sub_f32 v58, v58, v3
  v_sub_f32 v59, v59, v3
  v_sub_f32 v60, v60, v3
  v_sub_f32 v61, v61, v3
  v_sub_f32 v62, v62, v3
  v_sub_f32 v63, v63, v3
  v_exp_f32 v192, v32
  v_sub_f32 v111, 0, v3
  v_exp_f32 v193, v33
  v_sub_f32 v110, 0, v3
  v_cvt_pk_bf16_f32 v112, v192, v193
  v_exp_f32 v194, v34
  v_sub_f32 v109, 0, v3
  v_exp_f32 v195, v35
  v_sub_f32 v108, 0, v3
  v_cvt_pk_bf16_f32 v113, v194, v195
  v_exp_f32 v196, v36
  v_sub_f32 v107, 0, v2
  v_exp_f32 v197, v37
  v_sub_f32 v106, 0, v2
  v_cvt_pk_bf16_f32 v114, v196, v197
  v_exp_f32 v198, v38
  v_sub_f32 v105, 0, v2
  v_exp_f32 v199, v39
  v_sub_f32 v104, 0, v2
  v_cvt_pk_bf16_f32 v115, v198, v199
  v_exp_f32 v192, v40
  v_sub_f32 v103, 0, v1
  v_exp_f32 v193, v41
  v_sub_f32 v102, 0, v1
  v_cvt_pk_bf16_f32 v116, v192, v193
  v_exp_f32 v194, v42
  v_sub_f32 v101, 0, v1
  v_exp_f32 v195, v43
  v_sub_f32 v100, 0, v1
  v_cvt_pk_bf16_f32 v117, v194, v195
  v_exp_f32 v196, v44
  v_sub_f32 v99, 0, v0
  v_exp_f32 v197, v45
  v_sub_f32 v98, 0, v0
  v_cvt_pk_bf16_f32 v118, v196, v197
  v_sub_f32 v96, 0, v0
  v_sub_f32 v97, 0, v0
  s_mov_b32 s72, 33792
  s_mov_b32 s73, s61
  s_add_u32 s76, s61, 135168
  s_mov_b32 s74, 65536
  s_mov_b32 s75, 0
  v_add_u32 v252, s72, v247
  v_add_u32 v253, s72, v248
  s_waitcnt vmcnt(22) lgkmcnt(0)
  s_barrier
.p2align 6
KA_LOOP:
  v_mfma_f32_16x16x32_bf16 v[64:67], a[192:195], v[128:131], v[96:99]
  v_exp_f32 v198, v46
  v_mfma_f32_16x16x32_bf16 v[64:67], a[196:199], v[132:135], v[64:67]
  ds_read_b128 a[128:131], v252 offset:0
  v_mfma_f32_16x16x32_bf16 v[64:67], a[200:203], v[136:139], v[64:67]
  v_exp_f32 v199, v47
  v_mfma_f32_16x16x32_bf16 v[64:67], a[204:207], v[140:143], v[64:67]
  ds_read_b128 a[132:135], v252 offset:64
  v_cvt_pk_bf16_f32 v119, v198, v199
  v_mfma_f32_16x16x32_bf16 v[68:71], a[208:211], v[128:131], v[96:99]
  s_add_u32 m0, s73, 0
  v_exp_f32 v192, v48
  v_mfma_f32_16x16x32_bf16 v[68:71], a[212:215], v[132:135], v[68:71]
  buffer_load_dwordx4 v243, s[36:39], s74 offen offset:0 lds
  v_mfma_f32_16x16x32_bf16 v[68:71], a[216:219], v[136:139], v[68:71]
  v_exp_f32 v193, v49
  v_mfma_f32_16x16x32_bf16 v[68:71], a[220:223], v[140:143], v[68:71]
  ds_read_b128 a[136:139], v252 offset:128
  v_cvt_pk_bf16_f32 v120, v192, v193
  v_mfma_f32_16x16x32_bf16 v[72:75], a[192:195], v[144:147], v[100:103]
  v_exp_f32 v194, v50
  v_mfma_f32_16x16x32_bf16 v[72:75], a[196:199], v[148:151], v[72:75]
  ds_read_b128 a[140:143], v252 offset:192
  v_mfma_f32_16x16x32_bf16 v[72:75], a[200:203], v[152:155], v[72:75]
  v_exp_f32 v195, v51
  v_mfma_f32_16x16x32_bf16 v[72:75], a[204:207], v[156:159], v[72:75]
  ds_read_b128 a[144:147], v252 offset:1024
  v_cvt_pk_bf16_f32 v121, v194, v195
  v_mfma_f32_16x16x32_bf16 v[76:79], a[208:211], v[144:147], v[100:103]
  v_exp_f32 v196, v52
  v_mfma_f32_16x16x32_bf16 v[76:79], a[212:215], v[148:151], v[76:79]
  ds_read_b128 a[148:151], v252 offset:1088
  v_mfma_f32_16x16x32_bf16 v[76:79], a[216:219], v[152:155], v[76:79]
  v_exp_f32 v197, v53
  v_mfma_f32_16x16x32_bf16 v[76:79], a[220:223], v[156:159], v[76:79]
  v_cvt_pk_bf16_f32 v122, v196, v197
  v_mfma_f32_16x16x32_bf16 a[0:3], a[224:227], v[112:115], a[0:3]
  v_exp_f32 v198, v54
  v_mfma_f32_16x16x32_bf16 a[32:35], a[224:227], v[116:119], a[32:35]
  ds_read_b128 a[152:155], v252 offset:1152
  v_mfma_f32_16x16x32_bf16 a[4:7], a[228:231], v[112:115], a[4:7]
  v_exp_f32 v199, v55
  v_mfma_f32_16x16x32_bf16 a[36:39], a[228:231], v[116:119], a[36:39]
  buffer_load_dwordx4 v243, s[36:39], s74 offen offset:1024 lds
  v_mfma_f32_16x16x32_bf16 a[8:11], a[232:235], v[112:115], a[8:11]
  ds_read_b128 a[156:159], v252 offset:1216
  v_cvt_pk_bf16_f32 v123, v198, v199
  v_mfma_f32_16x16x32_bf16 a[40:43], a[232:235], v[116:119], a[40:43]
  v_exp_f32 v192, v56
  v_mfma_f32_16x16x32_bf16 a[12:15], a[236:239], v[112:115], a[12:15]
  ds_read_b64_tr_b16 a[160:161], v253 offset:25344
  v_mfma_f32_16x16x32_bf16 a[44:47], a[236:239], v[116:119], a[44:47]
  v_exp_f32 v193, v57
  v_mfma_f32_16x16x32_bf16 a[16:19], a[240:243], v[112:115], a[16:19]
  ds_read_b64_tr_b16 a[162:163], v253 offset:25600
  v_cvt_pk_bf16_f32 v124, v192, v193
  v_mfma_f32_16x16x32_bf16 a[48:51], a[240:243], v[116:119], a[48:51]
  v_exp_f32 v194, v58
  v_mfma_f32_16x16x32_bf16 a[20:23], a[244:247], v[112:115], a[20:23]
  ds_read_b64_tr_b16 a[164:165], v253 offset:25376
  v_mfma_f32_16x16x32_bf16 a[52:55], a[244:247], v[116:119], a[52:55]
  v_exp_f32 v195, v59
  v_mfma_f32_16x16x32_bf16 a[24:27], a[248:251], v[112:115], a[24:27]
  ds_read_b64_tr_b16 a[166:167], v253 offset:25632
  v_cvt_pk_bf16_f32 v125, v194, v195
  v_mfma_f32_16x16x32_bf16 a[56:59], a[248:251], v[116:119], a[56:59]
  v_exp_f32 v196, v60
  v_mfma_f32_16x16x32_bf16 a[28:31], a[252:255], v[112:115], a[28:31]
  v_mfma_f32_16x16x32_bf16 a[60:63], a[252:255], v[116:119], a[60:63]
  v_exp_f32 v197, v61
  v_mfma_f32_16x16x32_bf16 v[212:215], v[236:239], v[112:115], v[212:215]
  s_add_u32 m0, s73, 8448
  ds_read_b64_tr_b16 a[168:169], v253 offset:25408
  v_cvt_pk_bf16_f32 v126, v196, v197
  v_mfma_f32_16x16x32_bf16 v[216:219], v[236:239], v[116:119], v[216:219]
  buffer_load_dwordx4 v244, s[36:39], s74 offen offset:0 lds
  v_mfma_f32_16x16x32_bf16 v[80:83], a[192:195], v[160:163], v[104:107]
  v_exp_f32 v198, v62
  v_mfma_f32_16x16x32_bf16 v[80:83], a[196:199], v[164:167], v[80:83]
  ds_read_b64_tr_b16 a[170:171], v253 offset:25664
  v_mfma_f32_16x16x32_bf16 v[80:83], a[200:203], v[168:171], v[80:83]
  v_exp_f32 v199, v63
  v_mfma_f32_16x16x32_bf16 v[80:83], a[204:207], v[172:175], v[80:83]
  ds_read_b64_tr_b16 a[172:173], v253 offset:25440
  v_cvt_pk_bf16_f32 v127, v198, v199
  v_mfma_f32_16x16x32_bf16 v[84:87], a[208:211], v[160:163], v[104:107]
  v_exp_f32 v192, v64
  v_mfma_f32_16x16x32_bf16 v[84:87], a[212:215], v[164:167], v[84:87]
  ds_read_b64_tr_b16 a[174:175], v253 offset:25696
  v_mfma_f32_16x16x32_bf16 v[84:87], a[216:219], v[168:171], v[84:87]
  v_exp_f32 v193, v65
  v_mfma_f32_16x16x32_bf16 v[84:87], a[220:223], v[172:175], v[84:87]
  ds_read_b64_tr_b16 a[176:177], v253 offset:25472
  v_cvt_pk_bf16_f32 v112, v192, v193
  v_mfma_f32_16x16x32_bf16 v[88:91], a[192:195], v[176:179], v[108:111]
  v_exp_f32 v194, v66
  v_mfma_f32_16x16x32_bf16 v[88:91], a[196:199], v[180:183], v[88:91]
  ds_read_b64_tr_b16 a[178:179], v253 offset:25728
  v_mfma_f32_16x16x32_bf16 v[88:91], a[200:203], v[184:187], v[88:91]
  v_exp_f32 v195, v67
  v_mfma_f32_16x16x32_bf16 v[88:91], a[204:207], v[188:191], v[88:91]
  v_cvt_pk_bf16_f32 v113, v194, v195
  v_mfma_f32_16x16x32_bf16 v[92:95], a[208:211], v[176:179], v[108:111]
  v_exp_f32 v196, v68
  v_mfma_f32_16x16x32_bf16 v[92:95], a[212:215], v[180:183], v[92:95]
  buffer_load_dwordx4 v244, s[36:39], s74 offen offset:1024 lds
  v_mfma_f32_16x16x32_bf16 v[92:95], a[216:219], v[184:187], v[92:95]
  ds_read_b64_tr_b16 a[180:181], v253 offset:25504
  v_mfma_f32_16x16x32_bf16 v[92:95], a[220:223], v[188:191], v[92:95]
  v_exp_f32 v197, v69
  v_mfma_f32_16x16x32_bf16 a[64:67], a[224:227], v[120:123], a[64:67]
  ds_read_b64_tr_b16 a[182:183], v253 offset:25760
  v_cvt_pk_bf16_f32 v114, v196, v197
  v_mfma_f32_16x16x32_bf16 a[96:99], a[224:227], v[124:127], a[96:99]
  v_exp_f32 v198, v70
  v_mfma_f32_16x16x32_bf16 a[68:71], a[228:231], v[120:123], a[68:71]
  ds_read_b64_tr_b16 a[184:185], v253 offset:25536
  v_mfma_f32_16x16x32_bf16 a[100:103], a[228:231], v[124:127], a[100:103]
  v_exp_f32 v199, v71
  v_mfma_f32_16x16x32_bf16 a[72:75], a[232:235], v[120:123], a[72:75]
  ds_read_b64_tr_b16 a[186:187], v253 offset:25792
  v_cvt_pk_bf16_f32 v115, v198, v199
  v_mfma_f32_16x16x32_bf16 a[104:107], a[232:235], v[124:127], a[104:107]
  v_exp_f32 v192, v72
  v_mfma_f32_16x16x32_bf16 a[76:79], a[236:239], v[120:123], a[76:79]
  ds_read_b64_tr_b16 a[188:189], v253 offset:25568
  v_mfma_f32_16x16x32_bf16 a[108:111], a[236:239], v[124:127], a[108:111]
  v_exp_f32 v193, v73
  v_mfma_f32_16x16x32_bf16 a[80:83], a[240:243], v[120:123], a[80:83]
  ds_read_b64_tr_b16 a[190:191], v253 offset:25824
  v_cvt_pk_bf16_f32 v116, v192, v193
  v_mfma_f32_16x16x32_bf16 a[112:115], a[240:243], v[124:127], a[112:115]
  v_exp_f32 v194, v74
  v_mfma_f32_16x16x32_bf16 a[84:87], a[244:247], v[120:123], a[84:87]
  s_add_u32 m0, s73, 25344
  v_add_u32 v255, 1, v255
  v_mfma_f32_16x16x32_bf16 a[116:119], a[244:247], v[124:127], a[116:119]
  buffer_load_dwordx4 v245, s[40:43], s74 offen offset:0 lds
  v_mfma_f32_16x16x32_bf16 a[88:91], a[248:251], v[120:123], a[88:91]
  v_exp_f32 v195, v75
  v_mfma_f32_16x16x32_bf16 a[120:123], a[248:251], v[124:127], a[120:123]
  v_cvt_pk_bf16_f32 v117, v194, v195
  v_mfma_f32_16x16x32_bf16 a[92:95], a[252:255], v[120:123], a[92:95]
  v_exp_f32 v196, v76
  v_mfma_f32_16x16x32_bf16 a[124:127], a[252:255], v[124:127], a[124:127]
  v_mfma_f32_16x16x32_bf16 v[220:223], v[236:239], v[120:123], v[220:223]
  s_waitcnt lgkmcnt(0)
  v_exp_f32 v197, v77
  v_mfma_f32_16x16x32_bf16 v[224:227], v[236:239], v[124:127], v[224:227]
  s_cmp_eq_u32 s75, 31
  v_cvt_pk_bf16_f32 v118, v196, v197
  s_cbranch_scc1 KA_LAST
  v_mfma_f32_16x16x32_bf16 v[32:35], a[128:131], v[128:131], v[96:99]
  v_exp_f32 v198, v78
  v_mfma_f32_16x16x32_bf16 v[32:35], a[132:135], v[132:135], v[32:35]
  ds_read_b128 a[192:195], v252 offset:8448
  ds_read_b128 a[196:199], v252 offset:8512
  v_mfma_f32_16x16x32_bf16 v[32:35], a[136:139], v[136:139], v[32:35]
  v_exp_f32 v199, v79
  v_mfma_f32_16x16x32_bf16 v[32:35], a[140:143], v[140:143], v[32:35]
  ds_read_b128 a[200:203], v252 offset:8576
  v_cvt_pk_bf16_f32 v119, v198, v199
  v_mfma_f32_16x16x32_bf16 v[36:39], a[144:147], v[128:131], v[96:99]
  v_exp_f32 v192, v80
  v_mfma_f32_16x16x32_bf16 v[36:39], a[148:151], v[132:135], v[36:39]
  v_exp_f32 v193, v81
  v_mfma_f32_16x16x32_bf16 v[36:39], a[152:155], v[136:139], v[36:39]
  s_add_u32 m0, s73, 26144
  ds_read_b128 a[204:207], v252 offset:8640
  v_cvt_pk_bf16_f32 v120, v192, v193
  v_mfma_f32_16x16x32_bf16 v[36:39], a[156:159], v[140:143], v[36:39]
  buffer_load_dwordx4 v245, s[40:43], s74 offen offset:256 lds
  v_mfma_f32_16x16x32_bf16 v[40:43], a[128:131], v[144:147], v[100:103]
  v_exp_f32 v194, v82
  v_mfma_f32_16x16x32_bf16 v[40:43], a[132:135], v[148:151], v[40:43]
  ds_read_b128 a[208:211], v252 offset:9472
  ds_read_b128 a[212:215], v252 offset:9536
  v_mfma_f32_16x16x32_bf16 v[40:43], a[136:139], v[152:155], v[40:43]
  v_exp_f32 v195, v83
  v_mfma_f32_16x16x32_bf16 v[40:43], a[140:143], v[156:159], v[40:43]
  ds_read_b128 a[216:219], v252 offset:9600
  v_cvt_pk_bf16_f32 v121, v194, v195
  v_mfma_f32_16x16x32_bf16 v[44:47], a[144:147], v[144:147], v[100:103]
  v_exp_f32 v196, v84
  v_mfma_f32_16x16x32_bf16 v[44:47], a[148:151], v[148:151], v[44:47]
  ds_read_b128 a[220:223], v252 offset:9664
  ds_read_b64_tr_b16 a[224:225], v253 offset:16896
  v_mfma_f32_16x16x32_bf16 v[44:47], a[152:155], v[152:155], v[44:47]
  v_exp_f32 v197, v85
  v_mfma_f32_16x16x32_bf16 v[44:47], a[156:159], v[156:159], v[44:47]
  ds_read_b64_tr_b16 a[226:227], v253 offset:17152
  v_cvt_pk_bf16_f32 v122, v196, v197
  v_mfma_f32_16x16x32_bf16 a[0:3], a[160:163], v[112:115], a[0:3]
  v_exp_f32 v198, v86
  v_mfma_f32_16x16x32_bf16 a[32:35], a[160:163], v[116:119], a[32:35]
  ds_read_b64_tr_b16 a[228:229], v253 offset:16928
  v_mfma_f32_16x16x32_bf16 a[4:7], a[164:167], v[112:115], a[4:7]
  v_exp_f32 v199, v87
  v_mfma_f32_16x16x32_bf16 a[36:39], a[164:167], v[116:119], a[36:39]
  ds_read_b64_tr_b16 a[230:231], v253 offset:17184
  v_cvt_pk_bf16_f32 v123, v198, v199
  v_mfma_f32_16x16x32_bf16 a[8:11], a[168:171], v[112:115], a[8:11]
  s_add_u32 m0, s73, 16896
  v_exp_f32 v192, v88
  v_mfma_f32_16x16x32_bf16 a[40:43], a[168:171], v[116:119], a[40:43]
  buffer_load_dwordx4 v246, s[40:43], s74 offen offset:0 lds
  v_mfma_f32_16x16x32_bf16 a[12:15], a[172:175], v[112:115], a[12:15]
  ds_read_b64_tr_b16 a[232:233], v253 offset:16960
  ds_read_b64_tr_b16 a[234:235], v253 offset:17216
  v_mfma_f32_16x16x32_bf16 a[44:47], a[172:175], v[116:119], a[44:47]
  v_exp_f32 v193, v89
  v_mfma_f32_16x16x32_bf16 a[16:19], a[176:179], v[112:115], a[16:19]
  ds_read_b64_tr_b16 a[236:237], v253 offset:16992
  v_cvt_pk_bf16_f32 v124, v192, v193
  v_mfma_f32_16x16x32_bf16 a[48:51], a[176:179], v[116:119], a[48:51]
  v_exp_f32 v194, v90
  v_mfma_f32_16x16x32_bf16 a[20:23], a[180:183], v[112:115], a[20:23]
  ds_read_b64_tr_b16 a[238:239], v253 offset:17248
  ds_read_b64_tr_b16 a[240:241], v253 offset:17024
  v_mfma_f32_16x16x32_bf16 a[52:55], a[180:183], v[116:119], a[52:55]
  v_exp_f32 v195, v91
  v_mfma_f32_16x16x32_bf16 a[24:27], a[184:187], v[112:115], a[24:27]
  ds_read_b64_tr_b16 a[242:243], v253 offset:17280
  v_cvt_pk_bf16_f32 v125, v194, v195
  v_mfma_f32_16x16x32_bf16 a[56:59], a[184:187], v[116:119], a[56:59]
  v_exp_f32 v196, v92
  v_mfma_f32_16x16x32_bf16 a[28:31], a[188:191], v[112:115], a[28:31]
  ds_read_b64_tr_b16 a[244:245], v253 offset:17056
  ds_read_b64_tr_b16 a[246:247], v253 offset:17312
  v_mfma_f32_16x16x32_bf16 a[60:63], a[188:191], v[116:119], a[60:63]
  v_exp_f32 v197, v93
  v_mfma_f32_16x16x32_bf16 v[212:215], v[236:239], v[112:115], v[212:215]
  ds_read_b64_tr_b16 a[248:249], v253 offset:17088
  v_cvt_pk_bf16_f32 v126, v196, v197
  v_mfma_f32_16x16x32_bf16 v[216:219], v[236:239], v[116:119], v[216:219]
  v_exp_f32 v198, v94
  v_mfma_f32_16x16x32_bf16 v[48:51], a[128:131], v[160:163], v[104:107]
  s_add_u32 m0, s73, 17696
  ds_read_b64_tr_b16 a[250:251], v253 offset:17344
  v_mfma_f32_16x16x32_bf16 v[48:51], a[132:135], v[164:167], v[48:51]
  buffer_load_dwordx4 v246, s[40:43], s74 offen offset:256 lds
  v_mfma_f32_16x16x32_bf16 v[48:51], a[136:139], v[168:171], v[48:51]
  v_exp_f32 v199, v95
  v_mfma_f32_16x16x32_bf16 v[48:51], a[140:143], v[172:175], v[48:51]
  s_add_u32 s74, s74, 16384
  ds_read_b64_tr_b16 a[252:253], v253 offset:17120
  v_cvt_pk_bf16_f32 v127, v198, v199
  v_mfma_f32_16x16x32_bf16 v[52:55], a[144:147], v[160:163], v[104:107]
  s_add_u32 s73, s73, 33792
  v_exp_f32 v192, v32
  v_mfma_f32_16x16x32_bf16 v[52:55], a[148:151], v[164:167], v[52:55]
  s_cmp_ge_u32 s73, s76
  v_exp_f32 v193, v33
  v_mfma_f32_16x16x32_bf16 v[52:55], a[152:155], v[168:171], v[52:55]
  s_cselect_b32 s73, s61, s73
  ds_read_b64_tr_b16 a[254:255], v253 offset:17376
  v_cvt_pk_bf16_f32 v112, v192, v193
  v_mfma_f32_16x16x32_bf16 v[52:55], a[156:159], v[172:175], v[52:55]
  s_add_u32 s72, s72, 33792
  v_exp_f32 v194, v34
  v_mfma_f32_16x16x32_bf16 v[56:59], a[128:131], v[176:179], v[108:111]
  s_cmp_ge_u32 s72, 135168
  v_mfma_f32_16x16x32_bf16 v[56:59], a[132:135], v[180:183], v[56:59]
  s_cselect_b32 s72, 0, s72
  v_exp_f32 v195, v35
  v_mfma_f32_16x16x32_bf16 v[56:59], a[136:139], v[184:187], v[56:59]
  s_add_u32 s75, s75, 1
  v_cvt_pk_bf16_f32 v113, v194, v195
  v_mfma_f32_16x16x32_bf16 v[56:59], a[140:143], v[188:191], v[56:59]
  v_exp_f32 v196, v36
  v_mfma_f32_16x16x32_bf16 v[60:63], a[144:147], v[176:179], v[108:111]
  s_waitcnt vmcnt(16) lgkmcnt(0)
  ds_write_b32 v254, v255
  v_mfma_f32_16x16x32_bf16 v[60:63], a[148:151], v[180:183], v[60:63]
  v_add_u32 v252, s72, v247
  v_add_u32 v253, s72, v248
  v_mfma_f32_16x16x32_bf16 v[60:63], a[152:155], v[184:187], v[60:63]
  v_exp_f32 v197, v37
  v_mfma_f32_16x16x32_bf16 v[60:63], a[156:159], v[188:191], v[60:63]
  v_cvt_pk_bf16_f32 v114, v196, v197
  v_mfma_f32_16x16x32_bf16 a[64:67], a[160:163], v[120:123], a[64:67]
  v_exp_f32 v198, v38
  v_mfma_f32_16x16x32_bf16 a[96:99], a[160:163], v[124:127], a[96:99]
  v_mfma_f32_16x16x32_bf16 a[68:71], a[164:167], v[120:123], a[68:71]
  v_exp_f32 v199, v39
  v_mfma_f32_16x16x32_bf16 a[100:103], a[164:167], v[124:127], a[100:103]
  v_cvt_pk_bf16_f32 v115, v198, v199
  v_mfma_f32_16x16x32_bf16 a[72:75], a[168:171], v[120:123], a[72:75]
  v_exp_f32 v192, v40
  v_mfma_f32_16x16x32_bf16 a[104:107], a[168:171], v[124:127], a[104:107]
  v_exp_f32 v193, v41
  v_mfma_f32_16x16x32_bf16 a[76:79], a[172:175], v[120:123], a[76:79]
  v_cvt_pk_bf16_f32 v116, v192, v193
  v_mfma_f32_16x16x32_bf16 a[108:111], a[172:175], v[124:127], a[108:111]
  v_exp_f32 v194, v42
  v_mfma_f32_16x16x32_bf16 a[80:83], a[176:179], v[120:123], a[80:83]
  ds_read_b128 v[228:231], v211
  v_mfma_f32_16x16x32_bf16 a[112:115], a[176:179], v[124:127], a[112:115]
  v_mfma_f32_16x16x32_bf16 a[84:87], a[180:183], v[120:123], a[84:87]
  v_exp_f32 v195, v43
  v_mfma_f32_16x16x32_bf16 a[116:119], a[180:183], v[124:127], a[116:119]
  v_cvt_pk_bf16_f32 v117, v194, v195
  v_mfma_f32_16x16x32_bf16 a[88:91], a[184:187], v[120:123], a[88:91]
  v_exp_f32 v196, v44
  v_mfma_f32_16x16x32_bf16 a[120:123], a[184:187], v[124:127], a[120:123]
  v_mfma_f32_16x16x32_bf16 a[92:95], a[188:191], v[120:123], a[92:95]
  s_waitcnt lgkmcnt(0)
  v_min3_u32 v228, v228, v229, v230
  v_min_u32 v228, v228, v231
  v_mfma_f32_16x16x32_bf16 a[124:127], a[188:191], v[124:127], a[124:127]
  v_exp_f32 v197, v45
  v_mfma_f32_16x16x32_bf16 v[220:223], v[236:239], v[120:123], v[220:223]
  s_cmp_lt_u32 s75, s87
  v_cmp_lt_u32 vcc, v228, v255
  v_mfma_f32_16x16x32_bf16 v[224:227], v[236:239], v[124:127], v[224:227]
  v_cvt_pk_bf16_f32 v118, v196, v197
  s_cbranch_vccnz KA_SPIN
KA_SPINB:
  s_cbranch_scc1 KA_LOOP
  s_branch KA_SIDE
KA_LAST:
  v_exp_f32 v198, v78
  s_nop 0
  v_exp_f32 v199, v79
  s_nop 0
  v_cvt_pk_bf16_f32 v119, v198, v199
  v_exp_f32 v192, v80
  v_exp_f32 v193, v81
  s_nop 0
  v_cvt_pk_bf16_f32 v120, v192, v193
  v_mfma_f32_16x16x32_bf16 v[212:215], v[236:239], v[112:115], v[212:215]
  v_exp_f32 v194, v82
  v_mfma_f32_16x16x32_bf16 v[216:219], v[236:239], v[116:119], v[216:219]
  v_exp_f32 v195, v83
  v_mfma_f32_16x16x32_bf16 a[0:3], a[160:163], v[112:115], a[0:3]
  v_cvt_pk_bf16_f32 v121, v194, v195
  v_exp_f32 v196, v84
  v_mfma_f32_16x16x32_bf16 a[32:35], a[160:163], v[116:119], a[32:35]
  v_exp_f32 v197, v85
  v_mfma_f32_16x16x32_bf16 a[4:7], a[164:167], v[112:115], a[4:7]
  v_cvt_pk_bf16_f32 v122, v196, v197
  v_exp_f32 v198, v86
  v_mfma_f32_16x16x32_bf16 a[36:39], a[164:167], v[116:119], a[36:39]
  v_exp_f32 v199, v87
  v_mfma_f32_16x16x32_bf16 a[8:11], a[168:171], v[112:115], a[8:11]
  v_cvt_pk_bf16_f32 v123, v198, v199
  v_exp_f32 v192, v88
  v_mfma_f32_16x16x32_bf16 a[40:43], a[168:171], v[116:119], a[40:43]
  v_exp_f32 v193, v89
  v_mfma_f32_16x16x32_bf16 a[12:15], a[172:175], v[112:115], a[12:15]
  v_cvt_pk_bf16_f32 v124, v192, v193
  v_exp_f32 v194, v90
  v_mfma_f32_16x16x32_bf16 a[44:47], a[172:175], v[116:119], a[44:47]
  v_exp_f32 v195, v91
  v_mfma_f32_16x16x32_bf16 a[16:19], a[176:179], v[112:115], a[16:19]
  v_cvt_pk_bf16_f32 v125, v194, v195
  v_exp_f32 v196, v92
  v_mfma_f32_16x16x32_bf16 a[48:51], a[176:179], v[116:119], a[48:51]
  v_exp_f32 v197, v93
  v_mfma_f32_16x16x32_bf16 a[20:23], a[180:183], v[112:115], a[20:23]
  v_cvt_pk_bf16_f32 v126, v196, v197
  v_exp_f32 v198, v94
  v_mfma_f32_16x16x32_bf16 a[52:55], a[180:183], v[116:119], a[52:55]
  v_exp_f32 v199, v95
  v_mfma_f32_16x16x32_bf16 a[24:27], a[184:187], v[112:115], a[24:27]
  v_cvt_pk_bf16_f32 v127, v198, v199
  v_mfma_f32_16x16x32_bf16 a[56:59], a[184:187], v[116:119], a[56:59]
  v_mfma_f32_16x16x32_bf16 a[28:31], a[188:191], v[112:115], a[28:31]
  v_mfma_f32_16x16x32_bf16 a[60:63], a[188:191], v[116:119], a[60:63]
  s_nop 1
  v_mfma_f32_16x16x32_bf16 v[220:223], v[236:239], v[120:123], v[220:223]
  v_mfma_f32_16x16x32_bf16 v[224:227], v[236:239], v[124:127], v[224:227]
  v_mfma_f32_16x16x32_bf16 a[64:67], a[160:163], v[120:123], a[64:67]
  v_mfma_f32_16x16x32_bf16 a[96:99], a[160:163], v[124:127], a[96:99]
  v_mfma_f32_16x16x32_bf16 a[68:71], a[164:167], v[120:123], a[68:71]
  v_mfma_f32_16x16x32_bf16 a[100:103], a[164:167], v[124:127], a[100:103]
  v_mfma_f32_16x16x32_bf16 a[72:75], a[168:171], v[120:123], a[72:75]
  v_mfma_f32_16x16x32_bf16 a[104:107], a[168:171], v[124:127], a[104:107]
  v_mfma_f32_16x16x32_bf16 a[76:79], a[172:175], v[120:123], a[76:79]
  v_mfma_f32_16x16x32_bf16 a[108:111], a[172:175], v[124:127], a[108:111]
  v_mfma_f32_16x16x32_bf16 a[80:83], a[176:179], v[120:123], a[80:83]
  v_mfma_f32_16x16x32_bf16 a[112:115], a[176:179], v[124:127], a[112:115]
  v_mfma_f32_16x16x32_bf16 a[84:87], a[180:183], v[120:123], a[84:87]
  v_mfma_f32_16x16x32_bf16 a[116:119], a[180:183], v[124:127], a[116:119]
  v_mfma_f32_16x16x32_bf16 a[88:91], a[184:187], v[120:123], a[88:91]
  v_mfma_f32_16x16x32_bf16 a[120:123], a[184:187], v[124:127], a[120:123]
  v_mfma_f32_16x16x32_bf16 a[92:95], a[188:191], v[120:123], a[92:95]
  v_mfma_f32_16x16x32_bf16 a[124:127], a[188:191], v[124:127], a[124:127]
  s_nop 7
  v_mov_b32 v208, 0x4e800000
  s_mov_b64 s[84:85], 0
  v_cmp_nle_f32 vcc, v212, v208
  v_rcp_f32 v204, v212
  s_or_b64 s[84:85], s[84:85], vcc
  v_cmp_nle_f32 vcc, v216, v208
  v_rcp_f32 v205, v216
  s_or_b64 s[84:85], s[84:85], vcc
  v_cmp_nle_f32 vcc, v220, v208
  v_rcp_f32 v206, v220
  s_or_b64 s[84:85], s[84:85], vcc
  v_cmp_nle_f32 vcc, v224, v208
  v_rcp_f32 v207, v224
  s_or_b64 s[84:85], s[84:85], vcc
KA_FIN:
  buffer_load_dword v24, v22, s[12:15], s70 offen sc1
  s_cmp_lg_u64 s[84:85], 0
  s_cselect_b32 s53, 1, 0
  v_mov_b32 v0, s53
  ds_or_b32 v210, v0
  s_lshl_b32 s52, s49, 14
  s_add_u32 s52, s52, s65
  v_accvgpr_read_b32 v32, a0
  v_accvgpr_read_b32 v33, a1
  v_accvgpr_read_b32 v34, a2
  s_and_b32 s33, s48, 1
  v_accvgpr_read_b32 v35, a3
  v_accvgpr_read_b32 v36, a4
  v_accvgpr_read_b32 v37, a5
  s_lshr_b32 s34, s48, 1
  v_accvgpr_read_b32 v38, a6
  v_accvgpr_read_b32 v39, a7
  v_pk_mul_f32 v[32:33], v[32:33], v[204:205] op_sel:[0,0] op_sel_hi:[1,0]
  v_lshrrev_b32 v16, 4, v240
  v_pk_mul_f32 v[34:35], v[34:35], v[204:205] op_sel:[0,0] op_sel_hi:[1,0]
  v_pk_mul_f32 v[36:37], v[36:37], v[204:205] op_sel:[0,0] op_sel_hi:[1,0]
  v_pk_mul_f32 v[38:39], v[38:39], v[204:205] op_sel:[0,0] op_sel_hi:[1,0]
  s_lshl_b32 s56, s26, 8
  v_cvt_pk_bf16_f32 v40, v32, v33
  v_cvt_pk_bf16_f32 v41, v34, v35
  v_cvt_pk_bf16_f32 v42, v36, v37
  s_add_u32 s56, s56, s55
  v_cvt_pk_bf16_f32 v43, v38, v39
  buffer_store_dwordx4 v[40:43], v30, s[44:47], s52 offen offset:0 sc1
  v_accvgpr_read_b32 v48, a32
  v_lshlrev_b32 v17, 10, v16
  v_accvgpr_read_b32 v49, a33
  v_accvgpr_read_b32 v50, a34
  v_accvgpr_read_b32 v51, a35
  v_add_u32 v17, s56, v17
  v_accvgpr_read_b32 v52, a36
  v_accvgpr_read_b32 v53, a37
  v_accvgpr_read_b32 v54, a38
  v_and_b32 v18, 1, v240
  v_accvgpr_read_b32 v55, a39
  v_pk_mul_f32 v[48:49], v[48:49], v[204:205] op_sel:[0,1] op_sel_hi:[1,1]
  v_pk_mul_f32 v[50:51], v[50:51], v[204:205] op_sel:[0,1] op_sel_hi:[1,1]
  v_lshl_add_u32 v17, v18, 4, v17
  v_pk_mul_f32 v[52:53], v[52:53], v[204:205] op_sel:[0,1] op_sel_hi:[1,1]
  v_pk_mul_f32 v[54:55], v[54:55], v[204:205] op_sel:[0,1] op_sel_hi:[1,1]
  v_cvt_pk_bf16_f32 v56, v48, v49
  v_bfe_u32 v18, v240, 1, 3
  v_cvt_pk_bf16_f32 v57, v50, v51
  v_cvt_pk_bf16_f32 v58, v52, v53
  v_cvt_pk_bf16_f32 v59, v54, v55
  v_xor_b32 v18, v18, v16
  buffer_store_dwordx4 v[56:59], v30, s[44:47], s52 offen offset:1024 sc1
  v_accvgpr_read_b32 v64, a64
  v_accvgpr_read_b32 v65, a65
  v_lshl_add_u32 v2, v18, 5, v17
  v_accvgpr_read_b32 v66, a66
  v_accvgpr_read_b32 v67, a67
  v_accvgpr_read_b32 v68, a68
  v_xor_b32 v18, 4, v18
  v_accvgpr_read_b32 v69, a69
  v_accvgpr_read_b32 v70, a70
  v_accvgpr_read_b32 v71, a71
  v_lshl_add_u32 v3, v18, 5, v17
  v_pk_mul_f32 v[64:65], v[64:65], v[206:207] op_sel:[0,0] op_sel_hi:[1,0]
  v_pk_mul_f32 v[66:67], v[66:67], v[206:207] op_sel:[0,0] op_sel_hi:[1,0]
  v_pk_mul_f32 v[68:69], v[68:69], v[206:207] op_sel:[0,0] op_sel_hi:[1,0]
  v_add_u32 v3, 3072, v3
  v_pk_mul_f32 v[70:71], v[70:71], v[206:207] op_sel:[0,0] op_sel_hi:[1,0]
  v_cvt_pk_bf16_f32 v72, v64, v65
  v_cvt_pk_bf16_f32 v73, v66, v67
  s_mul_i32 s57, s24, 44
  v_cvt_pk_bf16_f32 v74, v68, v69
  v_cvt_pk_bf16_f32 v75, v70, v71
  buffer_store_dwordx4 v[72:75], v31, s[44:47], s52 offen offset:0 sc1
  s_min_u32 s57, s57, 128
  v_accvgpr_read_b32 v80, a96
  v_accvgpr_read_b32 v81, a97
  v_accvgpr_read_b32 v82, a98
  s_lshl_b32 s56, s25, 1
  v_accvgpr_read_b32 v83, a99
  v_accvgpr_read_b32 v84, a100
  v_accvgpr_read_b32 v85, a101
  s_add_u32 s56, s56, s34
  v_accvgpr_read_b32 v86, a102
  v_accvgpr_read_b32 v87, a103
  v_pk_mul_f32 v[80:81], v[80:81], v[206:207] op_sel:[0,1] op_sel_hi:[1,1]
  s_mul_i32 s56, s56, 171
  v_pk_mul_f32 v[82:83], v[82:83], v[206:207] op_sel:[0,1] op_sel_hi:[1,1]
  v_pk_mul_f32 v[84:85], v[84:85], v[206:207] op_sel:[0,1] op_sel_hi:[1,1]
  v_pk_mul_f32 v[86:87], v[86:87], v[206:207] op_sel:[0,1] op_sel_hi:[1,1]
  s_add_u32 s56, s56, s57
  v_cvt_pk_bf16_f32 v88, v80, v81
  v_cvt_pk_bf16_f32 v89, v82, v83
  v_cvt_pk_bf16_f32 v90, v84, v85
  s_lshl_b32 s56, s56, 12
  v_cvt_pk_bf16_f32 v91, v86, v87
  buffer_store_dwordx4 v[88:91], v31, s[44:47], s52 offen offset:1024 sc1
  s_add_u32 s52, s52, 4096
  v_accvgpr_read_b32 v32, a8
  s_lshl_b32 s57, s33, 11
  v_accvgpr_read_b32 v33, a9
  v_accvgpr_read_b32 v34, a10
  v_accvgpr_read_b32 v35, a11
  s_add_u32 s56, s56, s57
  v_accvgpr_read_b32 v36, a12
  v_accvgpr_read_b32 v37, a13
  v_accvgpr_read_b32 v38, a14
  v_add_u32 v4, s56, v241
  v_accvgpr_read_b32 v39, a15
  v_pk_mul_f32 v[32:33], v[32:33], v[204:205] op_sel:[0,0] op_sel_hi:[1,0]
  v_pk_mul_f32 v[34:35], v[34:35], v[204:205] op_sel:[0,0] op_sel_hi:[1,0]
  s_lshl_b32 s51, s48, 11
  v_pk_mul_f32 v[36:37], v[36:37], v[204:205] op_sel:[0,0] op_sel_hi:[1,0]
  v_pk_mul_f32 v[38:39], v[38:39], v[204:205] op_sel:[0,0] op_sel_hi:[1,0]
  v_cvt_pk_bf16_f32 v40, v32, v33
  v_lshrrev_b32 v17, 2, v240
  v_cvt_pk_bf16_f32 v41, v34, v35
  v_cvt_pk_bf16_f32 v42, v36, v37
  v_cvt_pk_bf16_f32 v43, v38, v39
  v_lshlrev_b32 v17, 8, v17
  buffer_store_dwordx4 v[40:43], v30, s[44:47], s52 offen offset:0 sc1
  v_accvgpr_read_b32 v48, a40
  v_accvgpr_read_b32 v49, a41
  v_and_b32 v18, 3, v240
  v_accvgpr_read_b32 v50, a42
  v_accvgpr_read_b32 v51, a43
  v_accvgpr_read_b32 v52, a44
  v_lshl_add_u32 v17, v18, 3, v17
  v_accvgpr_read_b32 v53, a45
  v_accvgpr_read_b32 v54, a46
  v_accvgpr_read_b32 v55, a47
  v_bfe_u32 v18, v240, 2, 3
  v_pk_mul_f32 v[48:49], v[48:49], v[204:205] op_sel:[0,1] op_sel_hi:[1,1]
  v_pk_mul_f32 v[50:51], v[50:51], v[204:205] op_sel:[0,1] op_sel_hi:[1,1]
  v_pk_mul_f32 v[52:53], v[52:53], v[204:205] op_sel:[0,1] op_sel_hi:[1,1]
  s_lshl_b32 s62, s34, 2
  v_pk_mul_f32 v[54:55], v[54:55], v[204:205] op_sel:[0,1] op_sel_hi:[1,1]
  v_cvt_pk_bf16_f32 v56, v48, v49
  v_cvt_pk_bf16_f32 v57, v50, v51
  v_xor_b32 v18, s62, v18
  v_cvt_pk_bf16_f32 v58, v52, v53
  v_cvt_pk_bf16_f32 v59, v54, v55
  buffer_store_dwordx4 v[56:59], v30, s[44:47], s52 offen offset:1024 sc1
  v_xor_b32 v19, 0, v18
  v_accvgpr_read_b32 v64, a72
  v_accvgpr_read_b32 v65, a73
  v_accvgpr_read_b32 v66, a74
  v_lshl_add_u32 v6, v19, 5, v17
  v_accvgpr_read_b32 v67, a75
  v_accvgpr_read_b32 v68, a76
  v_accvgpr_read_b32 v69, a77
  v_xor_b32 v19, 1, v18
  v_accvgpr_read_b32 v70, a78
  v_accvgpr_read_b32 v71, a79
  v_pk_mul_f32 v[64:65], v[64:65], v[206:207] op_sel:[0,0] op_sel_hi:[1,0]
  v_lshl_add_u32 v7, v19, 5, v17
  v_pk_mul_f32 v[66:67], v[66:67], v[206:207] op_sel:[0,0] op_sel_hi:[1,0]
  v_pk_mul_f32 v[68:69], v[68:69], v[206:207] op_sel:[0,0] op_sel_hi:[1,0]
  v_pk_mul_f32 v[70:71], v[70:71], v[206:207] op_sel:[0,0] op_sel_hi:[1,0]
  v_xor_b32 v19, 2, v18
  v_cvt_pk_bf16_f32 v72, v64, v65
  v_cvt_pk_bf16_f32 v73, v66, v67
  v_cvt_pk_bf16_f32 v74, v68, v69
  v_lshl_add_u32 v8, v19, 5, v17
  v_cvt_pk_bf16_f32 v75, v70, v71
  buffer_store_dwordx4 v[72:75], v31, s[44:47], s52 offen offset:0 sc1
  v_accvgpr_read_b32 v80, a104
  v_xor_b32 v19, 3, v18
  v_accvgpr_read_b32 v81, a105
  v_accvgpr_read_b32 v82, a106
  v_accvgpr_read_b32 v83, a107
  v_lshl_add_u32 v9, v19, 5, v17
  v_accvgpr_read_b32 v84, a108
  v_accvgpr_read_b32 v85, a109
  v_accvgpr_read_b32 v86, a110
  v_accvgpr_read_b32 v87, a111
  v_pk_mul_f32 v[80:81], v[80:81], v[206:207] op_sel:[0,1] op_sel_hi:[1,1]
  v_pk_mul_f32 v[82:83], v[82:83], v[206:207] op_sel:[0,1] op_sel_hi:[1,1]
  v_pk_mul_f32 v[84:85], v[84:85], v[206:207] op_sel:[0,1] op_sel_hi:[1,1]
  v_pk_mul_f32 v[86:87], v[86:87], v[206:207] op_sel:[0,1] op_sel_hi:[1,1]
  v_cvt_pk_bf16_f32 v88, v80, v81
  v_cvt_pk_bf16_f32 v89, v82, v83
  v_cvt_pk_bf16_f32 v90, v84, v85
  v_cvt_pk_bf16_f32 v91, v86, v87
  buffer_store_dwordx4 v[88:91], v31, s[44:47], s52 offen offset:1024 sc1
  s_add_u32 s52, s52, 4096
  v_accvgpr_read_b32 v32, a16
  v_accvgpr_read_b32 v33, a17
  v_accvgpr_read_b32 v34, a18
  v_accvgpr_read_b32 v35, a19
  v_accvgpr_read_b32 v36, a20
  v_accvgpr_read_b32 v37, a21
  v_accvgpr_read_b32 v38, a22
  v_accvgpr_read_b32 v39, a23
  v_pk_mul_f32 v[32:33], v[32:33], v[204:205] op_sel:[0,0] op_sel_hi:[1,0]
  v_pk_mul_f32 v[34:35], v[34:35], v[204:205] op_sel:[0,0] op_sel_hi:[1,0]
  v_pk_mul_f32 v[36:37], v[36:37], v[204:205] op_sel:[0,0] op_sel_hi:[1,0]
  v_pk_mul_f32 v[38:39], v[38:39], v[204:205] op_sel:[0,0] op_sel_hi:[1,0]
  v_cvt_pk_bf16_f32 v40, v32, v33
  v_cvt_pk_bf16_f32 v41, v34, v35
  v_cvt_pk_bf16_f32 v42, v36, v37
  v_cvt_pk_bf16_f32 v43, v38, v39
  buffer_store_dwordx4 v[40:43], v30, s[44:47], s52 offen offset:0 sc1
  v_accvgpr_read_b32 v48, a48
  v_accvgpr_read_b32 v49, a49
  v_accvgpr_read_b32 v50, a50
  v_accvgpr_read_b32 v51, a51
  v_accvgpr_read_b32 v52, a52
  v_accvgpr_read_b32 v53, a53
  v_accvgpr_read_b32 v54, a54
  v_accvgpr_read_b32 v55, a55
  v_pk_mul_f32 v[48:49], v[48:49], v[204:205] op_sel:[0,1] op_sel_hi:[1,1]
  v_pk_mul_f32 v[50:51], v[50:51], v[204:205] op_sel:[0,1] op_sel_hi:[1,1]
  v_pk_mul_f32 v[52:53], v[52:53], v[204:205] op_sel:[0,1] op_sel_hi:[1,1]
  v_pk_mul_f32 v[54:55], v[54:55], v[204:205] op_sel:[0,1] op_sel_hi:[1,1]
  v_cvt_pk_bf16_f32 v56, v48, v49
  v_cvt_pk_bf16_f32 v57, v50, v51
  v_cvt_pk_bf16_f32 v58, v52, v53
  v_cvt_pk_bf16_f32 v59, v54, v55
  buffer_store_dwordx4 v[56:59], v30, s[44:47], s52 offen offset:1024 sc1
  v_accvgpr_read_b32 v64, a80
  v_accvgpr_read_b32 v65, a81
  v_accvgpr_read_b32 v66, a82
  v_accvgpr_read_b32 v67, a83
  v_accvgpr_read_b32 v68, a84
  v_accvgpr_read_b32 v69, a85
  v_accvgpr_read_b32 v70, a86
  v_accvgpr_read_b32 v71, a87
  v_pk_mul_f32 v[64:65], v[64:65], v[206:207] op_sel:[0,0] op_sel_hi:[1,0]
  v_pk_mul_f32 v[66:67], v[66:67], v[206:207] op_sel:[0,0] op_sel_hi:[1,0]
  v_pk_mul_f32 v[68:69], v[68:69], v[206:207] op_sel:[0,0] op_sel_hi:[1,0]
  v_pk_mul_f32 v[70:71], v[70:71], v[206:207] op_sel:[0,0] op_sel_hi:[1,0]
  v_cvt_pk_bf16_f32 v72, v64, v65
  v_cvt_pk_bf16_f32 v73, v66, v67
  v_cvt_pk_bf16_f32 v74, v68, v69
  v_cvt_pk_bf16_f32 v75, v70, v71
  buffer_store_dwordx4 v[72:75], v31, s[44:47], s52 offen offset:0 sc1
  v_accvgpr_read_b32 v80, a112
  v_accvgpr_read_b32 v81, a113
  v_accvgpr_read_b32 v82, a114
  v_accvgpr_read_b32 v83, a115
  v_accvgpr_read_b32 v84, a116
  v_accvgpr_read_b32 v85, a117
  v_accvgpr_read_b32 v86, a118
  v_accvgpr_read_b32 v87, a119
  v_pk_mul_f32 v[80:81], v[80:81], v[206:207] op_sel:[0,1] op_sel_hi:[1,1]
  v_pk_mul_f32 v[82:83], v[82:83], v[206:207] op_sel:[0,1] op_sel_hi:[1,1]
  v_pk_mul_f32 v[84:85], v[84:85], v[206:207] op_sel:[0,1] op_sel_hi:[1,1]
  v_pk_mul_f32 v[86:87], v[86:87], v[206:207] op_sel:[0,1] op_sel_hi:[1,1]
  v_cvt_pk_bf16_f32 v88, v80, v81
  v_cvt_pk_bf16_f32 v89, v82, v83
  v_cvt_pk_bf16_f32 v90, v84, v85
  v_cvt_pk_bf16_f32 v91, v86, v87
  buffer_store_dwordx4 v[88:91], v31, s[44:47], s52 offen offset:1024 sc1
  s_add_u32 s52, s52, 4096
  v_accvgpr_read_b32 v32, a24
  v_accvgpr_read_b32 v33, a25
  v_accvgpr_read_b32 v34, a26
  v_accvgpr_read_b32 v35, a27
  v_accvgpr_read_b32 v36, a28
  v_accvgpr_read_b32 v37, a29
  v_accvgpr_read_b32 v38, a30
  v_accvgpr_read_b32 v39, a31
  v_pk_mul_f32 v[32:33], v[32:33], v[204:205] op_sel:[0,0] op_sel_hi:[1,0]
  v_pk_mul_f32 v[34:35], v[34:35], v[204:205] op_sel:[0,0] op_sel_hi:[1,0]
  v_pk_mul_f32 v[36:37], v[36:37], v[204:205] op_sel:[0,0] op_sel_hi:[1,0]
  v_pk_mul_f32 v[38:39], v[38:39], v[204:205] op_sel:[0,0] op_sel_hi:[1,0]
  v_cvt_pk_bf16_f32 v40, v32, v33
  v_cvt_pk_bf16_f32 v41, v34, v35
  v_cvt_pk_bf16_f32 v42, v36, v37
  v_cvt_pk_bf16_f32 v43, v38, v39
  buffer_store_dwordx4 v[40:43], v30, s[44:47], s52 offen offset:0 sc1
  v_accvgpr_read_b32 v48, a56
  v_accvgpr_read_b32 v49, a57
  v_accvgpr_read_b32 v50, a58
  v_accvgpr_read_b32 v51, a59
  v_accvgpr_read_b32 v52, a60
  v_accvgpr_read_b32 v53, a61
  v_accvgpr_read_b32 v54, a62
  v_accvgpr_read_b32 v55, a63
  v_pk_mul_f32 v[48:49], v[48:49], v[204:205] op_sel:[0,1] op_sel_hi:[1,1]
  v_pk_mul_f32 v[50:51], v[50:51], v[204:205] op_sel:[0,1] op_sel_hi:[1,1]
  v_pk_mul_f32 v[52:53], v[52:53], v[204:205] op_sel:[0,1] op_sel_hi:[1,1]
  v_pk_mul_f32 v[54:55], v[54:55], v[204:205] op_sel:[0,1] op_sel_hi:[1,1]
  v_cvt_pk_bf16_f32 v56, v48, v49
  v_cvt_pk_bf16_f32 v57, v50, v51
  v_cvt_pk_bf16_f32 v58, v52, v53
  v_cvt_pk_bf16_f32 v59, v54, v55
  buffer_store_dwordx4 v[56:59], v30, s[44:47], s52 offen offset:1024 sc1
  v_accvgpr_read_b32 v64, a88
  v_accvgpr_read_b32 v65, a89
  v_accvgpr_read_b32 v66, a90
  v_accvgpr_read_b32 v67, a91
  v_accvgpr_read_b32 v68, a92
  v_accvgpr_read_b32 v69, a93
  v_accvgpr_read_b32 v70, a94
  v_accvgpr_read_b32 v71, a95
  v_pk_mul_f32 v[64:65], v[64:65], v[206:207] op_sel:[0,0] op_sel_hi:[1,0]
  v_pk_mul_f32 v[66:67], v[66:67], v[206:207] op_sel:[0,0] op_sel_hi:[1,0]
  v_pk_mul_f32 v[68:69], v[68:69], v[206:207] op_sel:[0,0] op_sel_hi:[1,0]
  v_pk_mul_f32 v[70:71], v[70:71], v[206:207] op_sel:[0,0] op_sel_hi:[1,0]
  v_cvt_pk_bf16_f32 v72, v64, v65
  v_cvt_pk_bf16_f32 v73, v66, v67
  v_cvt_pk_bf16_f32 v74, v68, v69
  v_cvt_pk_bf16_f32 v75, v70, v71
  buffer_store_dwordx4 v[72:75], v31, s[44:47], s52 offen offset:0 sc1
  v_accvgpr_read_b32 v80, a120
  v_accvgpr_read_b32 v81, a121
  v_accvgpr_read_b32 v82, a122
  v_accvgpr_read_b32 v83, a123
  v_accvgpr_read_b32 v84, a124
  v_accvgpr_read_b32 v85, a125
  v_accvgpr_read_b32 v86, a126
  v_accvgpr_read_b32 v87, a127
  v_pk_mul_f32 v[80:81], v[80:81], v[206:207] op_sel:[0,1] op_sel_hi:[1,1]
  v_pk_mul_f32 v[82:83], v[82:83], v[206:207] op_sel:[0,1] op_sel_hi:[1,1]
  v_pk_mul_f32 v[84:85], v[84:85], v[206:207] op_sel:[0,1] op_sel_hi:[1,1]
  v_pk_mul_f32 v[86:87], v[86:87], v[206:207] op_sel:[0,1] op_sel_hi:[1,1]
  v_cvt_pk_bf16_f32 v88, v80, v81
  v_cvt_pk_bf16_f32 v89, v82, v83
  v_cvt_pk_bf16_f32 v90, v84, v85
  v_cvt_pk_bf16_f32 v91, v86, v87
  buffer_store_dwordx4 v[88:91], v31, s[44:47], s52 offen offset:1024 sc1
  s_add_u32 s52, s52, 4096
  s_waitcnt vmcnt(16)
  v_cmp_eq_u32 vcc, s88, v23
  s_and_b32 s71, vcc_lo, s69
  v_cmp_eq_u32 vcc, s88, v24
  s_and_b32 s53, vcc_lo, vcc_hi
  s_and_b32 s54, s53, 0x1fffffff
  s_lshr_b32 s53, s53, s79
  s_and_b32 s53, s53, s80
  s_cmp_eq_u32 s54, 0x1fffffff
  s_cselect_b32 s54, s80, 0
  s_cmp_eq_u32 s24, 3
  s_cselect_b32 s53, s54, s53
  s_cmp_lg_u32 s48, 0
  s_cbranch_scc1 KF_NW0
  v_mov_b32 v1, s53
  ds_write_b32 v210, v1 offset:4
KF_NW0:
  s_waitcnt lgkmcnt(0)
  s_barrier
  ds_read_b64 v[0:1], v210
  s_waitcnt lgkmcnt(0)
  v_readfirstlane_b32 s53, v0
  v_readfirstlane_b32 s77, v1
  s_cmp_eq_u32 s53, 1
  s_cbranch_scc1 KA_FALL
  s_bcnt1_i32_b32 s53, s77
  s_mov_b32 s35, 99
  s_cmp_lt_u32 s53, 2
  s_cbranch_scc1 KF_ST
  s_mov_b32 s35, 0
  s_andn2_b32 s78, s80, s77
  s_ff1_i32_b32 s56, s77
  s_bitset0_b32 s77, s56
  s_lshl_b32 s56, s56, 17
  s_add_u32 m0, s51, 0
  s_lshr_b32 s57, s56, 3
  buffer_load_dwordx4 v2, s[4:7], s56 offen offset:0 lds
  buffer_load_dwordx4 v3, s[4:7], s56 offen offset:1024 lds
  s_add_u32 m0, s51, 8192
  s_add_u32 s56, s56, 32768
  buffer_load_dwordx4 v4, s[44:47], s57 offen offset:0 lds
  buffer_load_dwordx4 v4, s[44:47], s57 offen offset:1024 lds
  s_add_u32 m0, s51, 16384
  s_lshr_b32 s57, s56, 3
  buffer_load_dwordx4 v2, s[4:7], s56 offen offset:0 lds
  buffer_load_dwordx4 v3, s[4:7], s56 offen offset:1024 lds
  s_add_u32 m0, s51, 24576
  s_add_u32 s56, s56, 32768
  buffer_load_dwordx4 v4, s[44:47], s57 offen offset:0 lds
  buffer_load_dwordx4 v4, s[44:47], s57 offen offset:1024 lds
  s_add_u32 m0, s51, 32768
  s_lshr_b32 s57, s56, 3
  buffer_load_dwordx4 v2, s[4:7], s56 offen offset:0 lds
  buffer_load_dwordx4 v3, s[4:7], s56 offen offset:1024 lds
  s_add_u32 m0, s51, 40960
  s_add_u32 s56, s56, 32768
  buffer_load_dwordx4 v4, s[44:47], s57 offen offset:0 lds
  buffer_load_dwordx4 v4, s[44:47], s57 offen offset:1024 lds
  s_add_u32 m0, s51, 49152
  s_lshr_b32 s57, s56, 3
  buffer_load_dwordx4 v2, s[4:7], s56 offen offset:0 lds
  buffer_load_dwordx4 v3, s[4:7], s56 offen offset:1024 lds
  s_add_u32 m0, s51, 57344
  s_add_u32 s56, s56, 32768
  buffer_load_dwordx4 v4, s[44:47], s57 offen offset:0 lds
  buffer_load_dwordx4 v4, s[44:47], s57 offen offset:1024 lds
  s_ff1_i32_b32 s56, s77
  s_bitset0_b32 s77, s56
  s_lshl_b32 s56, s56, 17
  s_add_u32 m0, s51, 65536
  s_lshr_b32 s57, s56, 3
  buffer_load_dwordx4 v2, s[4:7], s56 offen offset:0 lds
  buffer_load_dwordx4 v3, s[4:7], s56 offen offset:1024 lds
  s_add_u32 m0, s51, 73728
  s_add_u32 s56, s56, 32768
  buffer_load_dwordx4 v4, s[44:47], s57 offen offset:0 lds
  buffer_load_dwordx4 v4, s[44:47], s57 offen offset:1024 lds
  s_add_u32 m0, s51, 81920
  s_lshr_b32 s57, s56, 3
  buffer_load_dwordx4 v2, s[4:7], s56 offen offset:0 lds
  buffer_load_dwordx4 v3, s[4:7], s56 offen offset:1024 lds
  s_add_u32 m0, s51, 90112
  s_add_u32 s56, s56, 32768
  buffer_load_dwordx4 v4, s[44:47], s57 offen offset:0 lds
  buffer_load_dwordx4 v4, s[44:47], s57 offen offset:1024 lds
KF_ST:
  s_lshl_b32 s63, s33, 2
  s_add_u32 s62, s24, 0
  s_and_b32 s62, s62, 3
  s_add_u32 s62, s62, s63
  s_lshl_b32 s62, s62, 10
  s_add_u32 s62, s62, 8192
  v_add_u32 v10, s62, v241
  s_add_u32 s62, s24, 1
  s_and_b32 s62, s62, 3
  s_add_u32 s62, s62, s63
  s_lshl_b32 s62, s62, 10
  s_add_u32 s62, s62, 8192
  v_add_u32 v11, s62, v241
  s_add_u32 s62, s24, 2
  s_and_b32 s62, s62, 3
  s_add_u32 s62, s62, s63
  s_lshl_b32 s62, s62, 10
  s_add_u32 s62, s62, 8192
  v_add_u32 v12, s62, v241
  s_add_u32 s62, s24, 3
  s_and_b32 s62, s62, 3
  s_add_u32 s62, s62, s63
  s_lshl_b32 s62, s62, 10
  s_add_u32 s62, s62, 8192
  v_add_u32 v13, s62, v241
  s_lshl_b32 s62, s25, 7
  s_lshl_b32 s63, s33, 6
  s_add_u32 s62, s62, s63
  s_lshl_b32 s63, s24, 4
  s_add_u32 s62, s62, s63
  s_lshl_b32 s62, s62, 10
  s_lshl_b32 s63, s26, 8
  s_add_u32 s62, s62, s63
  s_lshl_b32 s63, s34, 7
  s_add_u32 s62, s62, s63
  v_and_b32 v17, 15, v240
  v_lshlrev_b32 v17, 10, v17
  v_lshl_add_u32 v17, v16, 3, v17
  v_add_u32 v5, s62, v17
  s_cmp_eq_u32 s35, 0
  s_cbranch_scc0 KF_SLOW
  s_waitcnt vmcnt(16)
  s_mov_b64 exec, 1
  buffer_store_dword v21, v232, s[12:15], s81 offen sc1
  s_mov_b64 exec, -1
  s_mov_b32 s35, 99
KF_MAIN:
  s_add_u32 s58, s51, 98304
  s_mov_b32 s60, 0
  s_mov_b32 s62, 0xfffe0000
  s_mov_b32 s63, 32768
  s_barrier
  ds_read_b64_tr_b16 v[32:33], v6 offset:0
  ds_read_b64_tr_b16 v[34:35], v6 offset:4096
  ds_read_b128 v[64:67], v10 offset:0
  ds_read_b64_tr_b16 v[36:37], v7 offset:0
  ds_read_b64_tr_b16 v[38:39], v7 offset:4096
  ds_read_b64_tr_b16 v[40:41], v8 offset:0
  ds_read_b64_tr_b16 v[42:43], v8 offset:4096
  ds_read_b64_tr_b16 v[44:45], v9 offset:0
  ds_read_b64_tr_b16 v[46:47], v9 offset:4096
  ds_read_b128 v[68:71], v11 offset:0
  ds_read_b128 v[72:75], v12 offset:0
  ds_read_b128 v[76:79], v13 offset:0
  s_waitcnt lgkmcnt(3)
  v_mfma_f32_16x16x32_bf16 v[96:99], v[32:35], v[64:67], 0
  ds_read_b64_tr_b16 v[48:49], v6 offset:16384
  v_mfma_f32_16x16x32_bf16 v[100:103], v[36:39], v[64:67], 0
  ds_read_b64_tr_b16 v[50:51], v6 offset:20480
  v_add_u32 v6, 32768, v6
  v_mfma_f32_16x16x32_bf16 v[104:107], v[40:43], v[64:67], 0
  ds_read_b128 v[80:83], v10 offset:16384
  v_add_u32 v10, 32768, v10
  v_mfma_f32_16x16x32_bf16 v[108:111], v[44:47], v[64:67], 0
  s_waitcnt lgkmcnt(3)
  v_mfma_f32_16x16x32_bf16 v[112:115], v[32:35], v[68:71], 0
  ds_read_b64_tr_b16 v[52:53], v7 offset:16384
  v_mfma_f32_16x16x32_bf16 v[116:119], v[36:39], v[68:71], 0
  ds_read_b64_tr_b16 v[54:55], v7 offset:20480
  v_add_u32 v7, 32768, v7
  v_mfma_f32_16x16x32_bf16 v[120:123], v[40:43], v[68:71], 0
  ds_read_b64_tr_b16 v[56:57], v8 offset:16384
  v_mfma_f32_16x16x32_bf16 v[124:127], v[44:47], v[68:71], 0
  v_mfma_f32_16x16x32_bf16 v[128:131], v[32:35], v[72:75], 0
  ds_read_b64_tr_b16 v[58:59], v8 offset:20480
  v_add_u32 v8, 32768, v8
  v_mfma_f32_16x16x32_bf16 v[132:135], v[36:39], v[72:75], 0
  ds_read_b64_tr_b16 v[60:61], v9 offset:16384
  v_mfma_f32_16x16x32_bf16 v[136:139], v[40:43], v[72:75], 0
  ds_read_b64_tr_b16 v[62:63], v9 offset:20480
  v_add_u32 v9, 32768, v9
  v_mfma_f32_16x16x32_bf16 v[140:143], v[44:47], v[72:75], 0
  v_mfma_f32_16x16x32_bf16 v[144:147], v[32:35], v[76:79], 0
  ds_read_b128 v[84:87], v11 offset:16384
  v_add_u32 v11, 32768, v11
  v_mfma_f32_16x16x32_bf16 v[148:151], v[36:39], v[76:79], 0
  ds_read_b128 v[88:91], v12 offset:16384
  v_add_u32 v12, 32768, v12
  v_mfma_f32_16x16x32_bf16 v[152:155], v[40:43], v[76:79], 0
  ds_read_b128 v[92:95], v13 offset:16384
  v_add_u32 v13, 32768, v13
  v_mfma_f32_16x16x32_bf16 v[156:159], v[44:47], v[76:79], 0
.p2align 6
KB_LOOP:
  s_waitcnt vmcnt(9) lgkmcnt(3)
  s_barrier
  v_mfma_f32_16x16x32_bf16 v[96:99], v[48:51], v[80:83], v[96:99]
  ds_read_b64_tr_b16 v[32:33], v6 offset:0
  v_mfma_f32_16x16x32_bf16 v[100:103], v[52:55], v[80:83], v[100:103]
  ds_read_b64_tr_b16 v[34:35], v6 offset:4096
  v_mfma_f32_16x16x32_bf16 v[104:107], v[56:59], v[80:83], v[104:107]
  s_add_u32 m0, s58, 0
  ds_read_b128 v[64:67], v10 offset:0
  v_mfma_f32_16x16x32_bf16 v[108:111], v[60:63], v[80:83], v[108:111]
  s_waitcnt lgkmcnt(3)
  buffer_load_dwordx4 v2, s[4:7], s56 offen lds
  v_mfma_f32_16x16x32_bf16 v[112:115], v[48:51], v[84:87], v[112:115]
  s_lshr_b32 s57, s56, 3
  ds_read_b64_tr_b16 v[36:37], v7 offset:0
  v_mfma_f32_16x16x32_bf16 v[116:119], v[52:55], v[84:87], v[116:119]
  s_cmp_ge_u32 s56, s6
  ds_read_b64_tr_b16 v[38:39], v7 offset:4096
  v_mfma_f32_16x16x32_bf16 v[120:123], v[56:59], v[84:87], v[120:123]
  s_cselect_b32 s57, 0x7f000000, s57
  ds_read_b64_tr_b16 v[40:41], v8 offset:0
  v_mfma_f32_16x16x32_bf16 v[124:127], v[60:63], v[84:87], v[124:127]
  buffer_load_dwordx4 v3, s[4:7], s56 offen offset:1024 lds
  v_mfma_f32_16x16x32_bf16 v[128:131], v[48:51], v[88:91], v[128:131]
  s_add_u32 s56, s56, 32768
  ds_read_b64_tr_b16 v[42:43], v8 offset:4096
  v_mfma_f32_16x16x32_bf16 v[132:135], v[52:55], v[88:91], v[132:135]
  ds_read_b64_tr_b16 v[44:45], v9 offset:0
  v_mfma_f32_16x16x32_bf16 v[136:139], v[56:59], v[88:91], v[136:139]
  s_add_u32 m0, s58, 8192
  ds_read_b64_tr_b16 v[46:47], v9 offset:4096
  v_mfma_f32_16x16x32_bf16 v[140:143], v[60:63], v[88:91], v[140:143]
  buffer_load_dwordx4 v4, s[44:47], s57 offen lds
  v_mfma_f32_16x16x32_bf16 v[144:147], v[48:51], v[92:95], v[144:147]
  s_cmp_eq_u32 s63, 131072
  ds_read_b128 v[68:71], v11 offset:0
  v_mfma_f32_16x16x32_bf16 v[148:151], v[52:55], v[92:95], v[148:151]
  s_cselect_b32 s59, s62, 32768
  ds_read_b128 v[72:75], v12 offset:0
  v_mfma_f32_16x16x32_bf16 v[152:155], v[56:59], v[92:95], v[152:155]
  s_add_u32 s63, s63, s59
  ds_read_b128 v[76:79], v13 offset:0
  v_mfma_f32_16x16x32_bf16 v[156:159], v[60:63], v[92:95], v[156:159]
  s_waitcnt lgkmcnt(3)
  buffer_load_dwordx4 v4, s[44:47], s57 offen offset:1024 lds
  v_mfma_f32_16x16x32_bf16 v[96:99], v[32:35], v[64:67], v[96:99]
  s_cmp_eq_u32 s78, 0
  ds_read_b64_tr_b16 v[48:49], v6 offset:16384
  v_mfma_f32_16x16x32_bf16 v[100:103], v[36:39], v[64:67], v[100:103]
  s_cselect_b32 s66, 0x7f000000, s70
  ds_read_b64_tr_b16 v[50:51], v6 offset:20480
  v_add_u32 v6, s59, v6
  v_mfma_f32_16x16x32_bf16 v[104:107], v[40:43], v[64:67], v[104:107]
  s_add_u32 m0, s58, 16384
  ds_read_b128 v[80:83], v10 offset:16384
  v_add_u32 v10, s59, v10
  v_mfma_f32_16x16x32_bf16 v[108:111], v[44:47], v[64:67], v[108:111]
  s_waitcnt lgkmcnt(3)
  buffer_load_dwordx4 v2, s[4:7], s56 offen lds
  v_mfma_f32_16x16x32_bf16 v[112:115], v[32:35], v[68:71], v[112:115]
  s_lshr_b32 s57, s56, 3
  ds_read_b64_tr_b16 v[52:53], v7 offset:16384
  v_mfma_f32_16x16x32_bf16 v[116:119], v[36:39], v[68:71], v[116:119]
  s_cmp_ge_u32 s56, s6
  ds_read_b64_tr_b16 v[54:55], v7 offset:20480
  v_add_u32 v7, s59, v7
  v_mfma_f32_16x16x32_bf16 v[120:123], v[40:43], v[68:71], v[120:123]
  s_cselect_b32 s57, 0x7f000000, s57
  ds_read_b64_tr_b16 v[56:57], v8 offset:16384
  v_mfma_f32_16x16x32_bf16 v[124:127], v[44:47], v[68:71], v[124:127]
  buffer_load_dwordx4 v3, s[4:7], s56 offen offset:1024 lds
  v_mfma_f32_16x16x32_bf16 v[128:131], v[32:35], v[72:75], v[128:131]
  s_add_u32 s56, s56, 32768
  ds_read_b64_tr_b16 v[58:59], v8 offset:20480
  v_add_u32 v8, s59, v8
  v_mfma_f32_16x16x32_bf16 v[132:135], v[36:39], v[72:75], v[132:135]
  ds_read_b64_tr_b16 v[60:61], v9 offset:16384
  v_mfma_f32_16x16x32_bf16 v[136:139], v[40:43], v[72:75], v[136:139]
  s_add_u32 m0, s58, 24576
  ds_read_b64_tr_b16 v[62:63], v9 offset:20480
  v_add_u32 v9, s59, v9
  v_mfma_f32_16x16x32_bf16 v[140:143], v[44:47], v[72:75], v[140:143]
  s_add_u32 s58, s58, 32768
  buffer_load_dwordx4 v4, s[44:47], s57 offen lds
  v_mfma_f32_16x16x32_bf16 v[144:147], v[32:35], v[76:79], v[144:147]
  s_cmp_ge_u32 s58, 163840
  ds_read_b128 v[84:87], v11 offset:16384
  v_add_u32 v11, s59, v11
  v_mfma_f32_16x16x32_bf16 v[148:151], v[36:39], v[76:79], v[148:151]
  s_cselect_b32 s58, s51, s58
  ds_read_b128 v[88:91], v12 offset:16384
  v_add_u32 v12, s59, v12
  v_mfma_f32_16x16x32_bf16 v[152:155], v[40:43], v[76:79], v[152:155]
  s_cmp_eq_u32 s77, 0
  ds_read_b128 v[92:95], v13 offset:16384
  v_add_u32 v13, s59, v13
  v_mfma_f32_16x16x32_bf16 v[156:159], v[44:47], v[76:79], v[156:159]
  buffer_load_dwordx4 v4, s[44:47], s57 offen offset:1024 lds
  s_cbranch_scc1 KB_REFILL
KB_PICK:
  s_ff1_i32_b32 s56, s77
  s_bitset0_b32 s77, s56
  s_lshl_b32 s56, s56, 17
KB_PICKED:
  s_waitcnt vmcnt(8) lgkmcnt(3)
  s_barrier
  v_mfma_f32_16x16x32_bf16 v[96:99], v[48:51], v[80:83], v[96:99]
  ds_read_b64_tr_b16 v[32:33], v6 offset:0
  v_mfma_f32_16x16x32_bf16 v[100:103], v[52:55], v[80:83], v[100:103]
  ds_read_b64_tr_b16 v[34:35], v6 offset:4096
  buffer_load_dword v24, v22, s[12:15], s66 offen sc1
  v_mfma_f32_16x16x32_bf16 v[104:107], v[56:59], v[80:83], v[104:107]
  s_add_u32 m0, s58, 0
  ds_read_b128 v[64:67], v10 offset:0
  v_mfma_f32_16x16x32_bf16 v[108:111], v[60:63], v[80:83], v[108:111]
  s_waitcnt lgkmcnt(3)
  buffer_load_dwordx4 v2, s[4:7], s56 offen lds
  v_mfma_f32_16x16x32_bf16 v[112:115], v[48:51], v[84:87], v[112:115]
  s_lshr_b32 s57, s56, 3
  ds_read_b64_tr_b16 v[36:37], v7 offset:0
  v_mfma_f32_16x16x32_bf16 v[116:119], v[52:55], v[84:87], v[116:119]
  s_cmp_ge_u32 s56, s6
  ds_read_b64_tr_b16 v[38:39], v7 offset:4096
  v_mfma_f32_16x16x32_bf16 v[120:123], v[56:59], v[84:87], v[120:123]
  s_cselect_b32 s57, 0x7f000000, s57
  ds_read_b64_tr_b16 v[40:41], v8 offset:0
  v_mfma_f32_16x16x32_bf16 v[124:127], v[60:63], v[84:87], v[124:127]
  buffer_load_dwordx4 v3, s[4:7], s56 offen offset:1024 lds
  v_mfma_f32_16x16x32_bf16 v[128:131], v[48:51], v[88:91], v[128:131]
  s_add_u32 s56, s56, 32768
  ds_read_b64_tr_b16 v[42:43], v8 offset:4096
  v_mfma_f32_16x16x32_bf16 v[132:135], v[52:55], v[88:91], v[132:135]
  ds_read_b64_tr_b16 v[44:45], v9 offset:0
  v_mfma_f32_16x16x32_bf16 v[136:139], v[56:59], v[88:91], v[136:139]
  s_add_u32 m0, s58, 8192
  ds_read_b64_tr_b16 v[46:47], v9 offset:4096
  v_mfma_f32_16x16x32_bf16 v[140:143], v[60:63], v[88:91], v[140:143]
  buffer_load_dwordx4 v4, s[44:47], s57 offen lds
  v_mfma_f32_16x16x32_bf16 v[144:147], v[48:51], v[92:95], v[144:147]
  s_cmp_eq_u32 s63, 131072
  ds_read_b128 v[68:71], v11 offset:0
  v_mfma_f32_16x16x32_bf16 v[148:151], v[52:55], v[92:95], v[148:151]
  s_cselect_b32 s59, s62, 32768
  ds_read_b128 v[72:75], v12 offset:0
  v_mfma_f32_16x16x32_bf16 v[152:155], v[56:59], v[92:95], v[152:155]
  s_add_u32 s63, s63, s59
  ds_read_b128 v[76:79], v13 offset:0
  v_mfma_f32_16x16x32_bf16 v[156:159], v[60:63], v[92:95], v[156:159]
  s_waitcnt lgkmcnt(3)
  buffer_load_dwordx4 v4, s[44:47], s57 offen offset:1024 lds
  s_cmp_eq_u32 s60, 10
  s_cbranch_scc1 KB_DONE
  v_mfma_f32_16x16x32_bf16 v[96:99], v[32:35], v[64:67], v[96:99]
  s_add_u32 s60, s60, 1
  ds_read_b64_tr_b16 v[48:49], v6 offset:16384
  v_mfma_f32_16x16x32_bf16 v[100:103], v[36:39], v[64:67], v[100:103]
  ds_read_b64_tr_b16 v[50:51], v6 offset:20480
  v_add_u32 v6, s59, v6
  v_mfma_f32_16x16x32_bf16 v[104:107], v[40:43], v[64:67], v[104:107]
  s_add_u32 m0, s58, 16384
  ds_read_b128 v[80:83], v10 offset:16384
  v_add_u32 v10, s59, v10
  v_mfma_f32_16x16x32_bf16 v[108:111], v[44:47], v[64:67], v[108:111]
  s_waitcnt lgkmcnt(3)
  buffer_load_dwordx4 v2, s[4:7], s56 offen lds
  v_mfma_f32_16x16x32_bf16 v[112:115], v[32:35], v[68:71], v[112:115]
  s_lshr_b32 s57, s56, 3
  ds_read_b64_tr_b16 v[52:53], v7 offset:16384
  v_mfma_f32_16x16x32_bf16 v[116:119], v[36:39], v[68:71], v[116:119]
  s_cmp_ge_u32 s56, s6
  ds_read_b64_tr_b16 v[54:55], v7 offset:20480
  v_add_u32 v7, s59, v7
  v_mfma_f32_16x16x32_bf16 v[120:123], v[40:43], v[68:71], v[120:123]
  s_cselect_b32 s57, 0x7f000000, s57
  ds_read_b64_tr_b16 v[56:57], v8 offset:16384
  v_mfma_f32_16x16x32_bf16 v[124:127], v[44:47], v[68:71], v[124:127]
  buffer_load_dwordx4 v3, s[4:7], s56 offen offset:1024 lds
  v_mfma_f32_16x16x32_bf16 v[128:131], v[32:35], v[72:75], v[128:131]
  s_add_u32 s56, s56, 32768
  ds_read_b64_tr_b16 v[58:59], v8 offset:20480
  v_add_u32 v8, s59, v8
  v_mfma_f32_16x16x32_bf16 v[132:135], v[36:39], v[72:75], v[132:135]
  ds_read_b64_tr_b16 v[60:61], v9 offset:16384
  v_mfma_f32_16x16x32_bf16 v[136:139], v[40:43], v[72:75], v[136:139]
  s_add_u32 m0, s58, 24576
  ds_read_b64_tr_b16 v[62:63], v9 offset:20480
  v_add_u32 v9, s59, v9
  v_mfma_f32_16x16x32_bf16 v[140:143], v[44:47], v[72:75], v[140:143]
  s_add_u32 s58, s58, 32768
  buffer_load_dwordx4 v4, s[44:47], s57 offen lds
  v_mfma_f32_16x16x32_bf16 v[144:147], v[32:35], v[76:79], v[144:147]
  s_cmp_ge_u32 s58, 163840
  ds_read_b128 v[84:87], v11 offset:16384
  v_add_u32 v11, s59, v11
  v_mfma_f32_16x16x32_bf16 v[148:151], v[36:39], v[76:79], v[148:151]
  s_cselect_b32 s58, s51, s58
  ds_read_b128 v[88:91], v12 offset:16384
  v_add_u32 v12, s59, v12
  v_mfma_f32_16x16x32_bf16 v[152:155], v[40:43], v[76:79], v[152:155]
  ds_read_b128 v[92:95], v13 offset:16384
  v_add_u32 v13, s59, v13
  v_mfma_f32_16x16x32_bf16 v[156:159], v[44:47], v[76:79], v[156:159]
  buffer_load_dwordx4 v4, s[44:47], s57 offen offset:1024 lds
  s_branch KB_LOOP
KB_DONE:
  buffer_load_dwordx2 v[192:193], v5, s[20:23], 0 offen offset:0
  buffer_load_dwordx2 v[194:195], v5, s[20:23], 0 offen offset:32
  buffer_load_dwordx2 v[196:197], v5, s[20:23], 0 offen offset:64
  buffer_load_dwordx2 v[198:199], v5, s[20:23], 0 offen offset:96
  s_cmp_lg_u32 s71, s69
  s_cbranch_scc1 KF_PART
KF_PARTB:
  s_lshl_b32 s56, s24, 15
  s_add_u32 s56, s56, s27
  s_mov_b32 s58, 0xfffffffe
  s_waitcnt lgkmcnt(0)
  s_nop 2
  v_cvt_pk_bf16_f32 v168, v112, v113
  v_cvt_pk_bf16_f32 v169, v114, v115
  v_cvt_pk_bf16_f32 v170, v116, v117
  v_cvt_pk_bf16_f32 v171, v118, v119
  v_cvt_pk_bf16_f32 v172, v120, v121
  v_cvt_pk_bf16_f32 v173, v122, v123
  v_cvt_pk_bf16_f32 v174, v124, v125
  v_cvt_pk_bf16_f32 v175, v126, v127
  v_min_u32 v168, s58, v168
  v_min_u32 v169, s58, v169
  v_min_u32 v170, s58, v170
  v_min_u32 v171, s58, v171
  v_min_u32 v172, s58, v172
  v_min_u32 v173, s58, v173
  v_min_u32 v174, s58, v174
  v_min_u32 v175, s58, v175
  s_add_u32 s57, s24, 1
  s_and_b32 s57, s57, 3
  s_lshl_b32 s57, s57, 11
  s_add_u32 s57, s57, s56
  buffer_store_dwordx4 v[168:171], v241, s[12:15], s57 offen offset:0 sc1
  buffer_store_dwordx4 v[172:175], v241, s[12:15], s57 offen offset:1024 sc1
  v_cvt_pk_bf16_f32 v176, v128, v129
  v_cvt_pk_bf16_f32 v177, v130, v131
  v_cvt_pk_bf16_f32 v178, v132, v133
  v_cvt_pk_bf16_f32 v179, v134, v135
  v_cvt_pk_bf16_f32 v180, v136, v137
  v_cvt_pk_bf16_f32 v181, v138, v139
  v_cvt_pk_bf16_f32 v182, v140, v141
  v_cvt_pk_bf16_f32 v183, v142, v143
  v_min_u32 v176, s58, v176
  v_min_u32 v177, s58, v177
  v_min_u32 v178, s58, v178
  v_min_u32 v179, s58, v179
  v_min_u32 v180, s58, v180
  v_min_u32 v181, s58, v181
  v_min_u32 v182, s58, v182
  v_min_u32 v183, s58, v183
  s_add_u32 s57, s24, 2
  s_and_b32 s57, s57, 3
  s_lshl_b32 s57, s57, 11
  s_add_u32 s57, s57, s56
  buffer_store_dwordx4 v[176:179], v241, s[12:15], s57 offen offset:0 sc1
  buffer_store_dwordx4 v[180:183], v241, s[12:15], s57 offen offset:1024 sc1
  v_cvt_pk_bf16_f32 v184, v144, v145
  v_cvt_pk_bf16_f32 v185, v146, v147
  v_cvt_pk_bf16_f32 v186, v148, v149
  v_cvt_pk_bf16_f32 v187, v150, v151
  v_cvt_pk_bf16_f32 v188, v152, v153
  v_cvt_pk_bf16_f32 v189, v154, v155
  v_cvt_pk_bf16_f32 v190, v156, v157
  v_cvt_pk_bf16_f32 v191, v158, v159
  v_min_u32 v184, s58, v184
  v_min_u32 v185, s58, v185
  v_min_u32 v186, s58, v186
  v_min_u32 v187, s58, v187
  v_min_u32 v188, s58, v188
  v_min_u32 v189, s58, v189
  v_min_u32 v190, s58, v190
  v_min_u32 v191, s58, v191
  s_add_u32 s57, s24, 3
  s_and_b32 s57, s57, 3
  s_lshl_b32 s57, s57, 11
  s_add_u32 s57, s57, s56
  buffer_store_dwordx4 v[184:187], v241, s[12:15], s57 offen offset:0 sc1
  buffer_store_dwordx4 v[188:191], v241, s[12:15], s57 offen offset:1024 sc1
  s_mov_b32 s89, 0
KX_POLL:
  buffer_load_dwordx4 v[32:35], v241, s[12:15], s28 offen offset:0 sc1
  buffer_load_dwordx4 v[36:39], v241, s[12:15], s28 offen offset:1024 sc1
  buffer_load_dwordx4 v[40:43], v241, s[12:15], s29 offen offset:0 sc1
  buffer_load_dwordx4 v[44:47], v241, s[12:15], s29 offen offset:1024 sc1
  buffer_load_dwordx4 v[48:51], v241, s[12:15], s30 offen offset:0 sc1
  buffer_load_dwordx4 v[52:55], v241, s[12:15], s30 offen offset:1024 sc1
  s_add_u32 s89, s89, 1
  s_waitcnt vmcnt(0)
  v_max3_u32 v200, v32, v33, v34
  v_max3_u32 v201, v40, v41, v42
  v_max3_u32 v202, v48, v49, v50
  v_max3_u32 v200, v200, v35, v36
  v_max3_u32 v201, v201, v43, v44
  v_max3_u32 v202, v202, v51, v52
  v_max3_u32 v200, v200, v37, v38
  v_max3_u32 v201, v201, v45, v46
  v_max3_u32 v202, v202, v53, v54
  v_max_u32 v200, v200, v39
  v_max_u32 v201, v201, v47
  v_max_u32 v202, v202, v55
  v_max3_u32 v200, v200, v201, v202
  v_cmp_eq_u32 vcc, -1, v200
  s_cmp_ge_u32 s89, 0x40000
  s_cbranch_scc1 KX_GO
  s_cbranch_vccz KX_GO
  s_sleep 4
  s_branch KX_POLL
KX_GO:
  s_mov_b32 s56, 0xbfb8aa3b
  v_lshlrev_b32 v112, 16, v48
  v_and_b32 v113, v242, v48
  v_lshlrev_b32 v114, 16, v49
  v_and_b32 v115, v242, v49
  v_lshlrev_b32 v116, 16, v50
  v_and_b32 v117, v242, v50
  v_lshlrev_b32 v118, 16, v51
  v_and_b32 v119, v242, v51
  v_lshlrev_b32 v120, 16, v52
  v_and_b32 v121, v242, v52
  v_lshlrev_b32 v122, 16, v53
  v_and_b32 v123, v242, v53
  v_lshlrev_b32 v124, 16, v54
  v_and_b32 v125, v242, v54
  v_lshlrev_b32 v126, 16, v55
  v_and_b32 v127, v242, v55
  s_cmp_lg_u32 s24, 3
  s_cbranch_scc1 KB_NOSWAP
  v_swap_b32 v96, v112
  v_swap_b32 v97, v113
  v_swap_b32 v98, v114
  v_swap_b32 v99, v115
  v_swap_b32 v100, v116
  v_swap_b32 v101, v117
  v_swap_b32 v102, v118
  v_swap_b32 v103, v119
  v_swap_b32 v104, v120
  v_swap_b32 v105, v121
  v_swap_b32 v106, v122
  v_swap_b32 v107, v123
  v_swap_b32 v108, v124
  v_swap_b32 v109, v125
  v_swap_b32 v110, v126
  v_swap_b32 v111, v127
  v_cvt_pk_bf16_f32 v128, v112, v113
  v_cvt_pk_bf16_f32 v129, v114, v115
  v_cvt_pk_bf16_f32 v130, v116, v117
  v_cvt_pk_bf16_f32 v131, v118, v119
  v_cvt_pk_bf16_f32 v132, v120, v121
  v_cvt_pk_bf16_f32 v133, v122, v123
  v_cvt_pk_bf16_f32 v134, v124, v125
  v_cvt_pk_bf16_f32 v135, v126, v127
  v_lshlrev_b32 v112, 16, v128
  v_and_b32 v113, v242, v128
  v_lshlrev_b32 v114, 16, v129
  v_and_b32 v115, v242, v129
  v_lshlrev_b32 v116, 16, v130
  v_and_b32 v117, v242, v130
  v_lshlrev_b32 v118, 16, v131
  v_and_b32 v119, v242, v131
  v_lshlrev_b32 v120, 16, v132
  v_and_b32 v121, v242, v132
  v_lshlrev_b32 v122, 16, v133
  v_and_b32 v123, v242, v133
  v_lshlrev_b32 v124, 16, v134
  v_and_b32 v125, v242, v134
  v_lshlrev_b32 v126, 16, v135
  v_and_b32 v127, v242, v135
KB_NOSWAP:
  v_mul_f32 v128, s56, v112
  v_mul_f32 v129, s56, v113
  v_mul_f32 v130, s56, v114
  v_mul_f32 v131, s56, v115
  v_mul_f32 v132, s56, v116
  v_mul_f32 v133, s56, v117
  v_mul_f32 v134, s56, v118
  v_mul_f32 v135, s56, v119
  v_mul_f32 v136, s56, v120
  v_mul_f32 v137, s56, v121
  v_mul_f32 v138, s56, v122
  v_mul_f32 v139, s56, v123
  v_mul_f32 v140, s56, v124
  v_mul_f32 v141, s56, v125
  v_mul_f32 v142, s56, v126
  v_mul_f32 v143, s56, v127
  v_exp_f32 v128, v128
  v_exp_f32 v129, v129
  v_exp_f32 v130, v130
  v_exp_f32 v131, v131
  v_exp_f32 v132, v132
  v_exp_f32 v133, v133
  v_exp_f32 v134, v134
  v_exp_f32 v135, v135
  v_exp_f32 v136, v136
  v_exp_f32 v137, v137
  v_exp_f32 v138, v138
  v_exp_f32 v139, v139
  v_exp_f32 v140, v140
  v_exp_f32 v141, v141
  v_exp_f32 v142, v142
  v_exp_f32 v143, v143
  v_lshlrev_b32 v144, 16, v32
  v_and_b32 v145, v242, v32
  v_lshlrev_b32 v146, 16, v33
  v_and_b32 v147, v242, v33
  v_lshlrev_b32 v148, 16, v34
  v_and_b32 v149, v242, v34
  v_lshlrev_b32 v150, 16, v35
  v_and_b32 v151, v242, v35
  v_lshlrev_b32 v152, 16, v36
  v_and_b32 v153, v242, v36
  v_lshlrev_b32 v154, 16, v37
  v_and_b32 v155, v242, v37
  v_lshlrev_b32 v156, 16, v38
  v_and_b32 v157, v242, v38
  v_lshlrev_b32 v158, 16, v39
  v_and_b32 v159, v242, v39
  v_pk_add_f32 v[96:97], v[96:97], v[144:145]
  v_pk_add_f32 v[98:99], v[98:99], v[146:147]
  v_pk_add_f32 v[100:101], v[100:101], v[148:149]
  v_pk_add_f32 v[102:103], v[102:103], v[150:151]
  v_pk_add_f32 v[104:105], v[104:105], v[152:153]
  v_pk_add_f32 v[106:107], v[106:107], v[154:155]
  v_pk_add_f32 v[108:109], v[108:109], v[156:157]
  v_pk_add_f32 v[110:111], v[110:111], v[158:159]
  v_lshlrev_b32 v144, 16, v40
  v_and_b32 v145, v242, v40
  v_lshlrev_b32 v146, 16, v41
  v_and_b32 v147, v242, v41
  v_lshlrev_b32 v148, 16, v42
  v_and_b32 v149, v242, v42
  v_lshlrev_b32 v150, 16, v43
  v_and_b32 v151, v242, v43
  v_lshlrev_b32 v152, 16, v44
  v_and_b32 v153, v242, v44
  v_lshlrev_b32 v154, 16, v45
  v_and_b32 v155, v242, v45
  v_lshlrev_b32 v156, 16, v46
  v_and_b32 v157, v242, v46
  v_lshlrev_b32 v158, 16, v47
  v_and_b32 v159, v242, v47
  v_pk_add_f32 v[96:97], v[96:97], v[144:145]
  v_pk_add_f32 v[98:99], v[98:99], v[146:147]
  v_pk_add_f32 v[100:101], v[100:101], v[148:149]
  v_pk_add_f32 v[102:103], v[102:103], v[150:151]
  v_pk_add_f32 v[104:105], v[104:105], v[152:153]
  v_pk_add_f32 v[106:107], v[106:107], v[154:155]
  v_pk_add_f32 v[108:109], v[108:109], v[156:157]
  v_pk_add_f32 v[110:111], v[110:111], v[158:159]
  v_add_f32 v128, 1.0, v128
  v_add_f32 v129, 1.0, v129
  v_add_f32 v130, 1.0, v130
  v_add_f32 v131, 1.0, v131
  v_add_f32 v132, 1.0, v132
  v_add_f32 v133, 1.0, v133
  v_add_f32 v134, 1.0, v134
  v_add_f32 v135, 1.0, v135
  v_add_f32 v136, 1.0, v136
  v_add_f32 v137, 1.0, v137
  v_add_f32 v138, 1.0, v138
  v_add_f32 v139, 1.0, v139
  v_add_f32 v140, 1.0, v140
  v_add_f32 v141, 1.0, v141
  v_add_f32 v142, 1.0, v142
  v_add_f32 v143, 1.0, v143
  v_rcp_f32 v128, v128
  v_rcp_f32 v129, v129
  v_rcp_f32 v130, v130
  v_rcp_f32 v131, v131
  v_rcp_f32 v132, v132
  v_rcp_f32 v133, v133
  v_rcp_f32 v134, v134
  v_rcp_f32 v135, v135
  v_rcp_f32 v136, v136
  v_rcp_f32 v137, v137
  v_rcp_f32 v138, v138
  v_rcp_f32 v139, v139
  v_rcp_f32 v140, v140
  v_rcp_f32 v141, v141
  v_rcp_f32 v142, v142
  v_rcp_f32 v143, v143
  v_lshlrev_b32 v144, 16, v192
  v_and_b32 v145, v242, v192
  v_lshlrev_b32 v146, 16, v193
  v_and_b32 v147, v242, v193
  v_lshlrev_b32 v148, 16, v194
  v_and_b32 v149, v242, v194
  v_lshlrev_b32 v150, 16, v195
  v_and_b32 v151, v242, v195
  v_lshlrev_b32 v152, 16, v196
  v_and_b32 v153, v242, v196
  v_lshlrev_b32 v154, 16, v197
  v_and_b32 v155, v242, v197
  v_lshlrev_b32 v156, 16, v198
  v_and_b32 v157, v242, v198
  v_lshlrev_b32 v158, 16, v199
  v_and_b32 v159, v242, v199
  v_pk_mul_f32 v[112:113], v[112:113], v[128:129]
  v_pk_mul_f32 v[114:115], v[114:115], v[130:131]
  v_pk_mul_f32 v[116:117], v[116:117], v[132:133]
  v_pk_mul_f32 v[118:119], v[118:119], v[134:135]
  v_pk_mul_f32 v[120:121], v[120:121], v[136:137]
  v_pk_mul_f32 v[122:123], v[122:123], v[138:139]
  v_pk_mul_f32 v[124:125], v[124:125], v[140:141]
  v_pk_mul_f32 v[126:127], v[126:127], v[142:143]
  v_pk_fma_f32 v[144:145], v[96:97], v[112:113], v[144:145]
  v_pk_fma_f32 v[146:147], v[98:99], v[114:115], v[146:147]
  v_pk_fma_f32 v[148:149], v[100:101], v[116:117], v[148:149]
  v_pk_fma_f32 v[150:151], v[102:103], v[118:119], v[150:151]
  v_pk_fma_f32 v[152:153], v[104:105], v[120:121], v[152:153]
  v_pk_fma_f32 v[154:155], v[106:107], v[122:123], v[154:155]
  v_pk_fma_f32 v[156:157], v[108:109], v[124:125], v[156:157]
  v_pk_fma_f32 v[158:159], v[110:111], v[126:127], v[158:159]
  v_cvt_pk_bf16_f32 v128, v144, v145
  v_cvt_pk_bf16_f32 v129, v146, v147
  v_cvt_pk_bf16_f32 v130, v148, v149
  v_cvt_pk_bf16_f32 v131, v150, v151
  v_cvt_pk_bf16_f32 v132, v152, v153
  v_cvt_pk_bf16_f32 v133, v154, v155
  v_cvt_pk_bf16_f32 v134, v156, v157
  v_cvt_pk_bf16_f32 v135, v158, v159
  buffer_store_dwordx2 v[128:129], v5, s[8:11], 0 offen offset:0
  buffer_store_dwordx2 v[130:131], v5, s[8:11], 0 offen offset:32
  buffer_store_dwordx2 v[132:133], v5, s[8:11], 0 offen offset:64
  buffer_store_dwordx2 v[134:135], v5, s[8:11], 0 offen offset:96
KA_END:
  s_endpgm
KA_GSIDE:
  s_cmp_eq_u32 s87, 3
  s_cbranch_scc1 KA_GS2
  s_cmp_eq_u32 s87, 6
  s_cbranch_scc1 KA_GS3
  s_cmp_eq_u32 s87, 7
  s_cbranch_scc1 KA_GS4
  buffer_load_dword v161, v232, s[16:19], 0 offen sc1
  s_mov_b32 s87, 3
  s_branch KA_GEMM
KA_GS2:
  v_readfirstlane_b32 s88, v161
  s_cmp_lg_u32 s88, 0
  s_cbranch_scc0 KA_TKSP
KA_TKOK:
  s_lshl_b32 s53, s84, 3
  s_add_u32 s53, s53, 0x802000
  s_mov_b32 exec_lo, 1
  s_mov_b32 exec_hi, 1
  buffer_store_dwordx2 v[160:161], v162, s[12:15], s53 offen sc1
  s_mov_b64 exec, -1
  s_mov_b32 s87, 6
  s_branch KA_GEMM
KA_GS3:
  s_mov_b32 s87, 7
  s_cmp_ge_u32 s48, 2
  s_cbranch_scc1 KA_GEMM
  s_lshl_b32 s53, s50, 13
  s_cmp_eq_u32 s48, 1
  s_cbranch_scc1 KA_TV
  buffer_load_dword v249, v211, s[36:39], s53 offen
  s_branch KA_GEMM
KA_TV:
  s_add_u32 s53, s53, 8192
  buffer_load_dword v249, v211, s[40:43], s53 offen
  s_branch KA_GEMM
KA_GS4:
  s_lshl_b32 s85, s50, 2
  s_add_u32 s85, s85, s48
  s_lshl_b32 s85, s85, 9
  s_add_u32 s85, s85, 0x802000
  buffer_load_dwordx2 v[164:165], v213, s[12:15], s85 offen offset:0 sc1
  buffer_load_dwordx2 v[166:167], v213, s[12:15], s85 offen offset:128 sc1
  buffer_load_dwordx2 v[168:169], v212, s[12:15], s85 offen offset:0 sc1
  buffer_load_dwordx2 v[170:171], v212, s[12:15], s85 offen offset:128 sc1
  s_mov_b32 s87, 99
  s_branch KA_GEMM
KA_STW:
  s_add_u32 s89, s89, 1
  s_cmp_ge_u32 s89, 0x100000
  s_cbranch_scc1 KA_STOK
  s_sleep 2
  buffer_load_dwordx2 v[164:165], v213, s[12:15], s85 offen offset:0 sc1
  buffer_load_dwordx2 v[166:167], v213, s[12:15], s85 offen offset:128 sc1
  buffer_load_dwordx2 v[168:169], v212, s[12:15], s85 offen offset:0 sc1
  buffer_load_dwordx2 v[170:171], v212, s[12:15], s85 offen offset:128 sc1
  s_waitcnt vmcnt(0)
  s_branch KA_STC
KA_SIDE:
  s_cmp_eq_u32 s87, 16
  s_cbranch_scc1 KA_SIDE2
  s_cmp_eq_u32 s87, 29
  s_cbranch_scc1 KA_SIDE3
  s_cmp_gt_u32 s87, 16
  s_cbranch_scc1 KA_SIDET
  v_mov_b32 v4, -1
  v_mov_b32 v5, -1
  v_mov_b32 v6, -1
  v_mov_b32 v7, -1
  buffer_store_dwordx4 v[4:7], v241, s[12:15], s28 offen offset:0 sc1
  buffer_store_dwordx4 v[4:7], v241, s[12:15], s28 offen offset:1024 sc1
  buffer_store_dwordx4 v[4:7], v241, s[12:15], s29 offen offset:0 sc1
  buffer_store_dwordx4 v[4:7], v241, s[12:15], s29 offen offset:1024 sc1
  buffer_store_dwordx4 v[4:7], v241, s[12:15], s30 offen offset:0 sc1
  buffer_store_dwordx4 v[4:7], v241, s[12:15], s30 offen offset:1024 sc1
  s_mov_b32 s87, 16
  s_branch KA_LOOP
KA_SIDE2:
  s_lshl_b32 s67, s50, 2
  s_add_u32 s67, s67, s48
  s_lshl_b32 s67, s67, 7
  s_lshl_b32 s81, s49, 2
  s_add_u32 s81, s81, s67
  s_add_u32 s81, s81, 0x800000
  s_add_u32 s67, s67, 0x800000
  v_mov_b32 v21, s88
  s_mov_b64 exec, 1
  buffer_store_dword v21, v232, s[12:15], s81 offen sc1
  s_mov_b64 exec, -1
  s_add_u32 s81, s81, 4096
  s_lshl_b32 s70, s25, 8
  s_add_u32 s70, s70, 0x800000
  s_cmp_eq_u32 s24, 3
  s_cselect_b32 s53, 0, 4096
  s_add_u32 s70, s70, s53
  v_lshlrev_b32 v22, 2, v240
  s_mul_i32 s79, s24, 11
  s_movk_i32 s80, 0x7ff
  s_cmp_eq_u32 s24, 2
  s_cselect_b32 s80, 0x3ff, s80
  s_and_b32 s69, s49, 7
  s_lshl_b32 s69, 0x01010101, s69
  s_lshr_b32 s53, s2, 3
  s_mul_i32 s53, s53, 12
  s_lshr_b32 s53, s53, 5
  s_add_u32 s87, s53, 17
  s_branch KA_LOOP
KA_SIDE3:
  buffer_load_dword v23, v22, s[12:15], s67 offen sc1
  s_mov_b32 s87, 32
  s_branch KA_LOOP
KA_SIDET:
  s_and_b32 s53, s25, 7
  s_lshl_b32 s53, s53, 2
  s_add_u32 s53, s53, s48
  s_lshl_b32 s53, s53, 15
  s_lshl_b32 s54, s26, 8
  s_add_u32 s53, s53, s54
  v_lshrrev_b32 v1, 1, v240
  v_lshlrev_b32 v1, 10, v1
  v_and_b32 v2, 1, v240
  v_lshl_add_u32 v1, v2, 7, v1
  buffer_load_dword v249, v1, s[4:7], s53 offen
  s_add_u32 s53, s53, 1048576
  buffer_load_dword v249, v1, s[4:7], s53 offen
  s_mov_b32 s87, 29
  s_branch KA_LOOP
KA_TKSP:
  s_mov_b32 s85, 0
KA_TKS2:
  buffer_load_dword v161, v232, s[16:19], 0 offen sc1
  s_add_u32 s85, s85, 1
  s_waitcnt vmcnt(0)
  v_readfirstlane_b32 s88, v161
  s_cmp_ge_u32 s85, 0x100000
  s_cbranch_scc1 KA_TKOK
  s_cmp_eq_u32 s88, 0
  s_cbranch_scc1 KA_TKS2
  s_branch KA_TKOK
KF_PART:
  s_mov_b32 s89, 0
KF_PART2:
  buffer_load_dword v23, v22, s[12:15], s67 offen sc1
  s_add_u32 s89, s89, 1
  s_waitcnt vmcnt(0)
  v_cmp_eq_u32 vcc, s88, v23
  s_cmp_ge_u32 s89, 0x100000
  s_cbranch_scc1 KF_PARTB
  s_and_b32 s71, vcc_lo, s69
  s_cmp_eq_u32 s71, s69
  s_cbranch_scc1 KF_PARTB
  s_sleep 8
  s_branch KF_PART2
KB_REFILL:
  s_mov_b32 s56, 0x7f000000
  s_cmp_eq_u32 s78, 0
  s_cbranch_scc1 KB_PICKED
  s_mov_b32 s89, 0
  s_waitcnt vmcnt(16)
  s_branch KB_REF4
KB_REF2:
  buffer_load_dword v24, v22, s[12:15], s70 offen sc1
  s_add_u32 s89, s89, 1
  s_waitcnt vmcnt(0)
KB_REF4:
  v_cmp_eq_u32 vcc, s88, v24
  s_and_b32 s53, vcc_lo, vcc_hi
  s_and_b32 s54, s53, 0x1fffffff
  s_lshr_b32 s53, s53, s79
  s_and_b32 s53, s53, s80
  s_cmp_eq_u32 s54, 0x1fffffff
  s_cselect_b32 s54, s80, 0
  s_cmp_eq_u32 s24, 3
  s_cselect_b32 s53, s54, s53
  s_cmp_ge_u32 s89, 0x100000
  s_cbranch_scc1 KB_REF3
  s_cmp_eq_u32 s53, s80
  s_cbranch_scc1 KB_REF3
  s_sleep 8
  s_branch KB_REF2
KB_REF3:
  s_mov_b32 s77, s78
  s_mov_b32 s78, 0
  s_branch KB_PICK
KF_SLOW:
  buffer_load_dword v24, v22, s[12:15], s70 offen sc1
  s_waitcnt vmcnt(1)
  s_mov_b64 exec, 1
  buffer_store_dword v21, v232, s[12:15], s81 offen sc1
  s_mov_b64 exec, -1
  s_cmp_lg_u32 s48, 0
  s_cbranch_scc1 KF_SLW3
  s_mov_b32 s89, 0
  s_waitcnt vmcnt(1)
  s_branch KF_SLW5
KF_SLW2:
  buffer_load_dword v24, v22, s[12:15], s70 offen sc1
  s_add_u32 s89, s89, 1
  s_waitcnt vmcnt(0)
KF_SLW5:
  v_cmp_eq_u32 vcc, s88, v24
  s_and_b32 s53, vcc_lo, vcc_hi
  s_and_b32 s54, s53, 0x1fffffff
  s_lshr_b32 s53, s53, s79
  s_and_b32 s53, s53, s80
  s_cmp_eq_u32 s54, 0x1fffffff
  s_cselect_b32 s54, s80, 0
  s_cmp_eq_u32 s24, 3
  s_cselect_b32 s53, s54, s53
  s_cmp_ge_u32 s89, 0x100000
  s_cselect_b32 s53, s80, s53
  s_bcnt1_i32_b32 s54, s53
  s_cmp_ge_u32 s54, 2
  s_cbranch_scc1 KF_SLW4
  s_sleep 3
  s_branch KF_SLW2
KF_SLW4:
  v_mov_b32 v1, s53
  ds_write_b32 v210, v1 offset:8
  s_waitcnt lgkmcnt(0)
KF_SLW3:
  s_barrier
  ds_read_b32 v1, v210 offset:8
  s_waitcnt lgkmcnt(0)
  v_readfirstlane_b32 s77, v1
  s_andn2_b32 s78, s80, s77
  s_ff1_i32_b32 s56, s77
  s_bitset0_b32 s77, s56
  s_lshl_b32 s56, s56, 17
  s_add_u32 m0, s51, 0
  s_lshr_b32 s57, s56, 3
  buffer_load_dwordx4 v2, s[4:7], s56 offen offset:0 lds
  buffer_load_dwordx4 v3, s[4:7], s56 offen offset:1024 lds
  s_add_u32 m0, s51, 8192
  s_add_u32 s56, s56, 32768
  buffer_load_dwordx4 v4, s[44:47], s57 offen offset:0 lds
  buffer_load_dwordx4 v4, s[44:47], s57 offen offset:1024 lds
  s_add_u32 m0, s51, 16384
  s_lshr_b32 s57, s56, 3
  buffer_load_dwordx4 v2, s[4:7], s56 offen offset:0 lds
  buffer_load_dwordx4 v3, s[4:7], s56 offen offset:1024 lds
  s_add_u32 m0, s51, 24576
  s_add_u32 s56, s56, 32768
  buffer_load_dwordx4 v4, s[44:47], s57 offen offset:0 lds
  buffer_load_dwordx4 v4, s[44:47], s57 offen offset:1024 lds
  s_add_u32 m0, s51, 32768
  s_lshr_b32 s57, s56, 3
  buffer_load_dwordx4 v2, s[4:7], s56 offen offset:0 lds
  buffer_load_dwordx4 v3, s[4:7], s56 offen offset:1024 lds
  s_add_u32 m0, s51, 40960
  s_add_u32 s56, s56, 32768
  buffer_load_dwordx4 v4, s[44:47], s57 offen offset:0 lds
  buffer_load_dwordx4 v4, s[44:47], s57 offen offset:1024 lds
  s_add_u32 m0, s51, 49152
  s_lshr_b32 s57, s56, 3
  buffer_load_dwordx4 v2, s[4:7], s56 offen offset:0 lds
  buffer_load_dwordx4 v3, s[4:7], s56 offen offset:1024 lds
  s_add_u32 m0, s51, 57344
  s_add_u32 s56, s56, 32768
  buffer_load_dwordx4 v4, s[44:47], s57 offen offset:0 lds
  buffer_load_dwordx4 v4, s[44:47], s57 offen offset:1024 lds
  s_ff1_i32_b32 s56, s77
  s_bitset0_b32 s77, s56
  s_lshl_b32 s56, s56, 17
  s_add_u32 m0, s51, 65536
  s_lshr_b32 s57, s56, 3
  buffer_load_dwordx4 v2, s[4:7], s56 offen offset:0 lds
  buffer_load_dwordx4 v3, s[4:7], s56 offen offset:1024 lds
  s_add_u32 m0, s51, 73728
  s_add_u32 s56, s56, 32768
  buffer_load_dwordx4 v4, s[44:47], s57 offen offset:0 lds
  buffer_load_dwordx4 v4, s[44:47], s57 offen offset:1024 lds
  s_add_u32 m0, s51, 81920
  s_lshr_b32 s57, s56, 3
  buffer_load_dwordx4 v2, s[4:7], s56 offen offset:0 lds
  buffer_load_dwordx4 v3, s[4:7], s56 offen offset:1024 lds
  s_add_u32 m0, s51, 90112
  s_add_u32 s56, s56, 32768
  buffer_load_dwordx4 v4, s[44:47], s57 offen offset:0 lds
  buffer_load_dwordx4 v4, s[44:47], s57 offen offset:1024 lds
  buffer_load_dword v24, v22, s[12:15], s70 offen sc1
  s_waitcnt vmcnt(17)
  s_branch KF_MAIN
KA_SPIN:
  s_mov_b32 s89, 0
KA_SPIN2:
  ds_read_b128 v[228:231], v211
  s_add_u32 s89, s89, 1
  s_waitcnt lgkmcnt(0)
  v_min3_u32 v228, v228, v229, v230
  v_min_u32 v228, v228, v231
  v_cmp_lt_u32 vcc, v228, v255
  s_cmp_lt_u32 s89, 0x100000
  s_cbranch_scc0 KA_SPIN3
  s_cbranch_vccnz KA_SPIN2
KA_SPIN3:
  s_cmp_lt_u32 s75, s87
  s_branch KA_SPINB
KA_FALL:
  s_waitcnt vmcnt(0) lgkmcnt(0)
  s_barrier
  v_mov_b32 v0, 2
  ds_write_b32 v210, v0
  s_mov_b32 s64, 0
  s_add_u32 m0, s61, 0
  s_nop 0
  buffer_load_dwordx4 v243, s[36:39], s64 offen offset:0 lds
  buffer_load_dwordx4 v243, s[36:39], s64 offen offset:1024 lds
  s_add_u32 m0, s61, 8448
  s_nop 0
  buffer_load_dwordx4 v244, s[36:39], s64 offen offset:0 lds
  buffer_load_dwordx4 v244, s[36:39], s64 offen offset:1024 lds
  s_add_u32 m0, s61, 16896
  s_nop 0
  buffer_load_dwordx4 v246, s[40:43], s64 offen offset:0 lds
  s_add_u32 m0, s61, 17696
  s_nop 0
  buffer_load_dwordx4 v246, s[40:43], s64 offen offset:256 lds
  s_mov_b32 s64, 16384
  s_add_u32 m0, s61, 33792
  s_nop 0
  buffer_load_dwordx4 v243, s[36:39], s64 offen offset:0 lds
  buffer_load_dwordx4 v243, s[36:39], s64 offen offset:1024 lds
  s_add_u32 m0, s61, 42240
  s_nop 0
  buffer_load_dwordx4 v244, s[36:39], s64 offen offset:0 lds
  buffer_load_dwordx4 v244, s[36:39], s64 offen offset:1024 lds
  s_add_u32 m0, s61, 59136
  s_nop 0
  buffer_load_dwordx4 v245, s[40:43], s64 offen offset:0 lds
  s_add_u32 m0, s61, 59936
  s_nop 0
  buffer_load_dwordx4 v245, s[40:43], s64 offen offset:256 lds
  s_add_u32 m0, s61, 50688
  s_nop 0
  buffer_load_dwordx4 v246, s[40:43], s64 offen offset:0 lds
  s_add_u32 m0, s61, 51488
  s_nop 0
  buffer_load_dwordx4 v246, s[40:43], s64 offen offset:256 lds
  s_mov_b32 s64, 32768
  s_add_u32 m0, s61, 67584
  s_nop 0
  buffer_load_dwordx4 v243, s[36:39], s64 offen offset:0 lds
  buffer_load_dwordx4 v243, s[36:39], s64 offen offset:1024 lds
  s_add_u32 m0, s61, 76032
  s_nop 0
  buffer_load_dwordx4 v244, s[36:39], s64 offen offset:0 lds
  buffer_load_dwordx4 v244, s[36:39], s64 offen offset:1024 lds
  s_add_u32 m0, s61, 92928
  s_nop 0
  buffer_load_dwordx4 v245, s[40:43], s64 offen offset:0 lds
  s_add_u32 m0, s61, 93728
  s_nop 0
  buffer_load_dwordx4 v245, s[40:43], s64 offen offset:256 lds
  s_add_u32 m0, s61, 84480
  s_nop 0
  buffer_load_dwordx4 v246, s[40:43], s64 offen offset:0 lds
  s_add_u32 m0, s61, 85280
  s_nop 0
  buffer_load_dwordx4 v246, s[40:43], s64 offen offset:256 lds
  s_mov_b32 s64, 49152
  s_add_u32 m0, s61, 101376
  s_nop 0
  buffer_load_dwordx4 v243, s[36:39], s64 offen offset:0 lds
  buffer_load_dwordx4 v243, s[36:39], s64 offen offset:1024 lds
  s_add_u32 m0, s61, 109824
  s_nop 0
  buffer_load_dwordx4 v244, s[36:39], s64 offen offset:0 lds
  buffer_load_dwordx4 v244, s[36:39], s64 offen offset:1024 lds
  s_add_u32 m0, s61, 126720
  s_nop 0
  buffer_load_dwordx4 v245, s[40:43], s64 offen offset:0 lds
  s_add_u32 m0, s61, 127520
  s_nop 0
  buffer_load_dwordx4 v245, s[40:43], s64 offen offset:256 lds
  s_add_u32 m0, s61, 118272
  s_nop 0
  buffer_load_dwordx4 v246, s[40:43], s64 offen offset:0 lds
  s_add_u32 m0, s61, 119072
  s_nop 0
  buffer_load_dwordx4 v246, s[40:43], s64 offen offset:256 lds
  v_accvgpr_write_b32 a0, 0
  v_accvgpr_write_b32 a1, 0
  v_accvgpr_write_b32 a2, 0
  v_accvgpr_write_b32 a3, 0
  v_accvgpr_write_b32 a4, 0
  v_accvgpr_write_b32 a5, 0
  v_accvgpr_write_b32 a6, 0
  v_accvgpr_write_b32 a7, 0
  v_accvgpr_write_b32 a8, 0
  v_accvgpr_write_b32 a9, 0
  v_accvgpr_write_b32 a10, 0
  v_accvgpr_write_b32 a11, 0
  v_accvgpr_write_b32 a12, 0
  v_accvgpr_write_b32 a13, 0
  v_accvgpr_write_b32 a14, 0
  v_accvgpr_write_b32 a15, 0
  v_accvgpr_write_b32 a16, 0
  v_accvgpr_write_b32 a17, 0
  v_accvgpr_write_b32 a18, 0
  v_accvgpr_write_b32 a19, 0
  v_accvgpr_write_b32 a20, 0
  v_accvgpr_write_b32 a21, 0
  v_accvgpr_write_b32 a22, 0
  v_accvgpr_write_b32 a23, 0
  v_accvgpr_write_b32 a24, 0
  v_accvgpr_write_b32 a25, 0
  v_accvgpr_write_b32 a26, 0
  v_accvgpr_write_b32 a27, 0
  v_accvgpr_write_b32 a28, 0
  v_accvgpr_write_b32 a29, 0
  v_accvgpr_write_b32 a30, 0
  v_accvgpr_write_b32 a31, 0
  v_accvgpr_write_b32 a32, 0
  v_accvgpr_write_b32 a33, 0
  v_accvgpr_write_b32 a34, 0
  v_accvgpr_write_b32 a35, 0
  v_accvgpr_write_b32 a36, 0
  v_accvgpr_write_b32 a37, 0
  v_accvgpr_write_b32 a38, 0
  v_accvgpr_write_b32 a39, 0
  v_accvgpr_write_b32 a40, 0
  v_accvgpr_write_b32 a41, 0
  v_accvgpr_write_b32 a42, 0
  v_accvgpr_write_b32 a43, 0
  v_accvgpr_write_b32 a44, 0
  v_accvgpr_write_b32 a45, 0
  v_accvgpr_write_b32 a46, 0
  v_accvgpr_write_b32 a47, 0
  v_accvgpr_write_b32 a48, 0
  v_accvgpr_write_b32 a49, 0
  v_accvgpr_write_b32 a50, 0
  v_accvgpr_write_b32 a51, 0
  v_accvgpr_write_b32 a52, 0
  v_accvgpr_write_b32 a53, 0
  v_accvgpr_write_b32 a54, 0
  v_accvgpr_write_b32 a55, 0
  v_accvgpr_write_b32 a56, 0
  v_accvgpr_write_b32 a57, 0
  v_accvgpr_write_b32 a58, 0
  v_accvgpr_write_b32 a59, 0
  v_accvgpr_write_b32 a60, 0
  v_accvgpr_write_b32 a61, 0
  v_accvgpr_write_b32 a62, 0
  v_accvgpr_write_b32 a63, 0
  v_accvgpr_write_b32 a64, 0
  v_accvgpr_write_b32 a65, 0
  v_accvgpr_write_b32 a66, 0
  v_accvgpr_write_b32 a67, 0
  v_accvgpr_write_b32 a68, 0
  v_accvgpr_write_b32 a69, 0
  v_accvgpr_write_b32 a70, 0
  v_accvgpr_write_b32 a71, 0
  v_accvgpr_write_b32 a72, 0
  v_accvgpr_write_b32 a73, 0
  v_accvgpr_write_b32 a74, 0
  v_accvgpr_write_b32 a75, 0
  v_accvgpr_write_b32 a76, 0
  v_accvgpr_write_b32 a77, 0
  v_accvgpr_write_b32 a78, 0
  v_accvgpr_write_b32 a79, 0
  v_accvgpr_write_b32 a80, 0
  v_accvgpr_write_b32 a81, 0
  v_accvgpr_write_b32 a82, 0
  v_accvgpr_write_b32 a83, 0
  v_accvgpr_write_b32 a84, 0
  v_accvgpr_write_b32 a85, 0
  v_accvgpr_write_b32 a86, 0
  v_accvgpr_write_b32 a87, 0
  v_accvgpr_write_b32 a88, 0
  v_accvgpr_write_b32 a89, 0
  v_accvgpr_write_b32 a90, 0
  v_accvgpr_write_b32 a91, 0
  v_accvgpr_write_b32 a92, 0
  v_accvgpr_write_b32 a93, 0
  v_accvgpr_write_b32 a94, 0
  v_accvgpr_write_b32 a95, 0
  v_accvgpr_write_b32 a96, 0
  v_accvgpr_write_b32 a97, 0
  v_accvgpr_write_b32 a98, 0
  v_accvgpr_write_b32 a99, 0
  v_accvgpr_write_b32 a100, 0
  v_accvgpr_write_b32 a101, 0
  v_accvgpr_write_b32 a102, 0
  v_accvgpr_write_b32 a103, 0
  v_accvgpr_write_b32 a104, 0
  v_accvgpr_write_b32 a105, 0
  v_accvgpr_write_b32 a106, 0
  v_accvgpr_write_b32 a107, 0
  v_accvgpr_write_b32 a108, 0
  v_accvgpr_write_b32 a109, 0
  v_accvgpr_write_b32 a110, 0
  v_accvgpr_write_b32 a111, 0
  v_accvgpr_write_b32 a112, 0
  v_accvgpr_write_b32 a113, 0
  v_accvgpr_write_b32 a114, 0
  v_accvgpr_write_b32 a115, 0
  v_accvgpr_write_b32 a116, 0
  v_accvgpr_write_b32 a117, 0
  v_accvgpr_write_b32 a118, 0
  v_accvgpr_write_b32 a119, 0
  v_accvgpr_write_b32 a120, 0
  v_accvgpr_write_b32 a121, 0
  v_accvgpr_write_b32 a122, 0
  v_accvgpr_write_b32 a123, 0
  v_accvgpr_write_b32 a124, 0
  v_accvgpr_write_b32 a125, 0
  v_accvgpr_write_b32 a126, 0
  v_accvgpr_write_b32 a127, 0
  v_mov_b32 v204, 0
  v_mov_b32 v205, 0
  v_mov_b32 v206, 0
  v_mov_b32 v207, 0
  v_mov_b32 v208, 0x49800000
  v_mov_b32 v252, v247
  v_mov_b32 v253, v248
  s_waitcnt vmcnt(24)
  s_barrier
  ds_read_b128 a[128:131], v252 offset:0
  ds_read_b128 a[132:135], v252 offset:64
  ds_read_b128 a[136:139], v252 offset:128
  ds_read_b128 a[140:143], v252 offset:192
  ds_read_b128 a[144:147], v252 offset:1024
  ds_read_b128 a[148:151], v252 offset:1088
  ds_read_b128 a[152:155], v252 offset:1152
  ds_read_b128 a[156:159], v252 offset:1216
  ds_read_b128 a[192:195], v252 offset:8448
  ds_read_b128 a[196:199], v252 offset:8512
  ds_read_b128 a[200:203], v252 offset:8576
  ds_read_b128 a[204:207], v252 offset:8640
  ds_read_b128 a[208:211], v252 offset:9472
  ds_read_b128 a[212:215], v252 offset:9536
  s_waitcnt lgkmcnt(6)
  v_mfma_f32_16x16x32_bf16 v[32:35], a[128:131], v[128:131], 0
  ds_read_b128 a[216:219], v252 offset:9600
  v_mfma_f32_16x16x32_bf16 v[32:35], a[132:135], v[132:135], v[32:35]
  ds_read_b128 a[220:223], v252 offset:9664
  v_mfma_f32_16x16x32_bf16 v[32:35], a[136:139], v[136:139], v[32:35]
  ds_read_b64_tr_b16 a[224:225], v253 offset:16896
  v_mfma_f32_16x16x32_bf16 v[32:35], a[140:143], v[140:143], v[32:35]
  ds_read_b64_tr_b16 a[226:227], v253 offset:17152
  v_mfma_f32_16x16x32_bf16 v[36:39], a[144:147], v[128:131], 0
  ds_read_b64_tr_b16 a[228:229], v253 offset:16928
  v_mfma_f32_16x16x32_bf16 v[36:39], a[148:151], v[132:135], v[36:39]
  ds_read_b64_tr_b16 a[230:231], v253 offset:17184
  v_mfma_f32_16x16x32_bf16 v[36:39], a[152:155], v[136:139], v[36:39]
  ds_read_b64_tr_b16 a[232:233], v253 offset:16960
  v_mfma_f32_16x16x32_bf16 v[36:39], a[156:159], v[140:143], v[36:39]
  ds_read_b64_tr_b16 a[234:235], v253 offset:17216
  v_mfma_f32_16x16x32_bf16 v[40:43], a[128:131], v[144:147], 0
  ds_read_b64_tr_b16 a[236:237], v253 offset:16992
  v_mfma_f32_16x16x32_bf16 v[40:43], a[132:135], v[148:151], v[40:43]
  ds_read_b64_tr_b16 a[238:239], v253 offset:17248
  v_mfma_f32_16x16x32_bf16 v[40:43], a[136:139], v[152:155], v[40:43]
  ds_read_b64_tr_b16 a[240:241], v253 offset:17024
  v_mfma_f32_16x16x32_bf16 v[40:43], a[140:143], v[156:159], v[40:43]
  ds_read_b64_tr_b16 a[242:243], v253 offset:17280
  v_mfma_f32_16x16x32_bf16 v[44:47], a[144:147], v[144:147], 0
  ds_read_b64_tr_b16 a[244:245], v253 offset:17056
  v_mfma_f32_16x16x32_bf16 v[44:47], a[148:151], v[148:151], v[44:47]
  ds_read_b64_tr_b16 a[246:247], v253 offset:17312
  v_mfma_f32_16x16x32_bf16 v[44:47], a[152:155], v[152:155], v[44:47]
  ds_read_b64_tr_b16 a[248:249], v253 offset:17088
  v_mfma_f32_16x16x32_bf16 v[44:47], a[156:159], v[156:159], v[44:47]
  ds_read_b64_tr_b16 a[250:251], v253 offset:17344
  v_mfma_f32_16x16x32_bf16 v[48:51], a[128:131], v[160:163], 0
  ds_read_b64_tr_b16 a[252:253], v253 offset:17120
  v_mfma_f32_16x16x32_bf16 v[48:51], a[132:135], v[164:167], v[48:51]
  ds_read_b64_tr_b16 a[254:255], v253 offset:17376
  v_mfma_f32_16x16x32_bf16 v[48:51], a[136:139], v[168:171], v[48:51]
  v_mov_b32 v212, 0
  v_mov_b32 v213, 0
  v_mfma_f32_16x16x32_bf16 v[48:51], a[140:143], v[172:175], v[48:51]
  v_mov_b32 v214, 0
  v_mov_b32 v215, 0
  v_mfma_f32_16x16x32_bf16 v[52:55], a[144:147], v[160:163], 0
  v_mov_b32 v216, 0
  v_mov_b32 v217, 0
  v_mfma_f32_16x16x32_bf16 v[52:55], a[148:151], v[164:167], v[52:55]
  v_mov_b32 v218, 0
  v_mov_b32 v219, 0
  v_mfma_f32_16x16x32_bf16 v[52:55], a[152:155], v[168:171], v[52:55]
  v_mov_b32 v220, 0
  v_mov_b32 v221, 0
  v_mfma_f32_16x16x32_bf16 v[52:55], a[156:159], v[172:175], v[52:55]
  v_mov_b32 v222, 0
  v_mov_b32 v223, 0
  v_mfma_f32_16x16x32_bf16 v[56:59], a[128:131], v[176:179], 0
  v_mov_b32 v224, 0
  v_mov_b32 v225, 0
  v_mfma_f32_16x16x32_bf16 v[56:59], a[132:135], v[180:183], v[56:59]
  v_mov_b32 v226, 0
  v_mov_b32 v227, 0
  v_mfma_f32_16x16x32_bf16 v[56:59], a[136:139], v[184:187], v[56:59]
  v_mfma_f32_16x16x32_bf16 v[56:59], a[140:143], v[188:191], v[56:59]
  v_mfma_f32_16x16x32_bf16 v[60:63], a[144:147], v[176:179], 0
  v_mfma_f32_16x16x32_bf16 v[60:63], a[148:151], v[180:183], v[60:63]
  v_mfma_f32_16x16x32_bf16 v[60:63], a[152:155], v[184:187], v[60:63]
  v_mfma_f32_16x16x32_bf16 v[60:63], a[156:159], v[188:191], v[60:63]
  s_nop 3
  v_max3_f32 v0, v32, v33, v34
  v_max3_f32 v1, v40, v41, v42
  v_max3_f32 v2, v48, v49, v50
  v_max3_f32 v3, v56, v57, v58
  v_max3_f32 v0, v0, v35, v36
  v_max3_f32 v1, v1, v43, v44
  v_max3_f32 v2, v2, v51, v52
  v_max3_f32 v3, v3, v59, v60
  v_max3_f32 v0, v0, v37, v38
  v_max3_f32 v1, v1, v45, v46
  v_max3_f32 v2, v2, v53, v54
  v_max3_f32 v3, v3, v61, v62
  v_max_f32 v0, v0, v39
  v_max_f32 v1, v1, v47
  v_max_f32 v2, v2, v55
  v_max_f32 v3, v3, v63
  v_mov_b32 v4, v0
  v_mov_b32 v5, v1
  v_mov_b32 v6, v2
  v_mov_b32 v7, v3
  s_nop 0
  v_permlane32_swap_b32 v0, v4
  v_permlane32_swap_b32 v1, v5
  v_permlane32_swap_b32 v2, v6
  v_permlane32_swap_b32 v3, v7
  v_max_f32 v0, v0, v4
  v_max_f32 v1, v1, v5
  v_max_f32 v2, v2, v6
  v_max_f32 v3, v3, v7
  v_mov_b32 v4, v0
  v_mov_b32 v5, v1
  v_mov_b32 v6, v2
  v_mov_b32 v7, v3
  s_nop 0
  v_permlane16_swap_b32 v0, v4
  v_permlane16_swap_b32 v1, v5
  v_permlane16_swap_b32 v2, v6
  v_permlane16_swap_b32 v3, v7
  v_max_f32 v0, v0, v4
  v_max_f32 v1, v1, v5
  v_max_f32 v2, v2, v6
  v_max_f32 v3, v3, v7
  v_sub_f32 v32, v32, v0
  v_sub_f32 v33, v33, v0
  v_sub_f32 v34, v34, v0
  v_sub_f32 v35, v35, v0
  v_sub_f32 v36, v36, v0
  v_sub_f32 v37, v37, v0
  v_sub_f32 v38, v38, v0
  v_sub_f32 v39, v39, v0
  v_sub_f32 v40, v40, v1
  v_sub_f32 v41, v41, v1
  v_sub_f32 v42, v42, v1
  v_sub_f32 v43, v43, v1
  v_sub_f32 v44, v44, v1
  v_sub_f32 v45, v45, v1
  v_sub_f32 v46, v46, v1
  v_sub_f32 v47, v47, v1
  v_sub_f32 v48, v48, v2
  v_sub_f32 v49, v49, v2
  v_sub_f32 v50, v50, v2
  v_sub_f32 v51, v51, v2
  v_sub_f32 v52, v52, v2
  v_sub_f32 v53, v53, v2
  v_sub_f32 v54, v54, v2
  v_sub_f32 v55, v55, v2
  v_sub_f32 v56, v56, v3
  v_sub_f32 v57, v57, v3
  v_sub_f32 v58, v58, v3
  v_sub_f32 v59, v59, v3
  v_sub_f32 v60, v60, v3
  v_sub_f32 v61, v61, v3
  v_sub_f32 v62, v62, v3
  v_sub_f32 v63, v63, v3
  v_exp_f32 v192, v32
  v_sub_f32 v111, 0, v3
  v_exp_f32 v193, v33
  v_sub_f32 v110, 0, v3
  v_exp_f32 v194, v34
  v_sub_f32 v109, 0, v3
  v_add_f32 v200, v192, v193
  v_cvt_pk_bf16_f32 v112, v192, v193
  v_exp_f32 v195, v35
  v_sub_f32 v108, 0, v3
  v_add_f32 v200, v194, v200
  v_exp_f32 v196, v36
  v_sub_f32 v107, 0, v2
  v_add_f32 v200, v195, v200
  v_cvt_pk_bf16_f32 v113, v194, v195
  v_exp_f32 v197, v37
  v_sub_f32 v106, 0, v2
  v_add_f32 v200, v196, v200
  v_exp_f32 v198, v38
  v_sub_f32 v105, 0, v2
  v_add_f32 v200, v197, v200
  v_cvt_pk_bf16_f32 v114, v196, v197
  v_exp_f32 v199, v39
  v_sub_f32 v104, 0, v2
  v_add_f32 v200, v198, v200
  v_exp_f32 v192, v40
  v_sub_f32 v103, 0, v1
  v_add_f32 v200, v199, v200
  v_cvt_pk_bf16_f32 v115, v198, v199
  v_exp_f32 v193, v41
  v_sub_f32 v102, 0, v1
  v_exp_f32 v194, v42
  v_sub_f32 v101, 0, v1
  v_add_f32 v201, v192, v193
  v_cvt_pk_bf16_f32 v116, v192, v193
  v_exp_f32 v195, v43
  v_sub_f32 v100, 0, v1
  v_add_f32 v201, v194, v201
  v_exp_f32 v196, v44
  v_sub_f32 v99, 0, v0
  v_add_f32 v201, v195, v201
  v_cvt_pk_bf16_f32 v117, v194, v195
  v_exp_f32 v197, v45
  v_sub_f32 v98, 0, v0
  v_add_f32 v201, v196, v201
  v_sub_f32 v96, 0, v0
  v_sub_f32 v97, 0, v0
  s_mov_b32 s72, 33792
  s_mov_b32 s73, s61
  s_add_u32 s76, s61, 135168
  s_mov_b32 s74, 65536
  s_mov_b32 s75, 0
  v_add_u32 v252, s72, v247
  v_add_u32 v253, s72, v248
  s_waitcnt vmcnt(16) lgkmcnt(0)
  s_barrier
KA_LOOP2:
  v_mfma_f32_16x16x32_bf16 v[64:67], a[192:195], v[128:131], v[96:99]
  v_exp_f32 v198, v46
  v_mfma_f32_16x16x32_bf16 v[64:67], a[196:199], v[132:135], v[64:67]
  ds_read_b128 a[128:131], v252 offset:0
  v_add_f32 v201, v197, v201
  v_cvt_pk_bf16_f32 v118, v196, v197
  v_mfma_f32_16x16x32_bf16 v[64:67], a[200:203], v[136:139], v[64:67]
  v_exp_f32 v199, v47
  v_mfma_f32_16x16x32_bf16 v[64:67], a[204:207], v[140:143], v[64:67]
  ds_read_b128 a[132:135], v252 offset:64
  v_add_f32 v201, v198, v201
  v_mfma_f32_16x16x32_bf16 v[68:71], a[208:211], v[128:131], v[96:99]
  s_add_u32 m0, s73, 0
  v_exp_f32 v192, v48
  v_mfma_f32_16x16x32_bf16 v[68:71], a[212:215], v[132:135], v[68:71]
  ds_read_b128 a[136:139], v252 offset:128
  v_add_f32 v201, v199, v201
  v_cvt_pk_bf16_f32 v119, v198, v199
  v_mfma_f32_16x16x32_bf16 v[68:71], a[216:219], v[136:139], v[68:71]
  buffer_load_dwordx4 v243, s[36:39], s74 offen offset:0 lds
  v_exp_f32 v193, v49
  v_mfma_f32_16x16x32_bf16 v[68:71], a[220:223], v[140:143], v[68:71]
  ds_read_b128 a[140:143], v252 offset:192
  v_max_f32 v209, v200, v201
  v_mfma_f32_16x16x32_bf16 v[72:75], a[192:195], v[144:147], v[100:103]
  v_exp_f32 v194, v50
  v_mfma_f32_16x16x32_bf16 v[72:75], a[196:199], v[148:151], v[72:75]
  ds_read_b128 a[144:147], v252 offset:1024
  v_add_f32 v202, v192, v193
  v_cvt_pk_bf16_f32 v120, v192, v193
  v_mfma_f32_16x16x32_bf16 v[72:75], a[200:203], v[152:155], v[72:75]
  v_exp_f32 v195, v51
  v_mfma_f32_16x16x32_bf16 v[72:75], a[204:207], v[156:159], v[72:75]
  ds_read_b128 a[148:151], v252 offset:1088
  v_add_f32 v202, v194, v202
  v_cmp_gt_f32 vcc, v209, v208
  v_mfma_f32_16x16x32_bf16 v[76:79], a[208:211], v[144:147], v[100:103]
  v_exp_f32 v196, v52
  v_mfma_f32_16x16x32_bf16 v[76:79], a[212:215], v[148:151], v[76:79]
  ds_read_b128 a[152:155], v252 offset:1152
  v_add_f32 v202, v195, v202
  v_cvt_pk_bf16_f32 v121, v194, v195
  v_mfma_f32_16x16x32_bf16 v[76:79], a[216:219], v[152:155], v[76:79]
  v_exp_f32 v197, v53
  v_mfma_f32_16x16x32_bf16 v[76:79], a[220:223], v[156:159], v[76:79]
  ds_read_b128 a[156:159], v252 offset:1216
  s_cbranch_vccnz KA_R11
KA_R11B:
  v_add_f32 v202, v196, v202
  v_mfma_f32_16x16x32_bf16 a[0:3], a[224:227], v[112:115], a[0:3]
  v_exp_f32 v198, v54
  v_mfma_f32_16x16x32_bf16 a[32:35], a[224:227], v[116:119], a[32:35]
  ds_read_b64_tr_b16 a[160:161], v253 offset:25344
  v_add_f32 v202, v197, v202
  v_cvt_pk_bf16_f32 v122, v196, v197
  v_mfma_f32_16x16x32_bf16 a[4:7], a[228:231], v[112:115], a[4:7]
  v_exp_f32 v199, v55
  v_mfma_f32_16x16x32_bf16 a[36:39], a[228:231], v[116:119], a[36:39]
  ds_read_b64_tr_b16 a[162:163], v253 offset:25600
  v_add_f32 v202, v198, v202
  v_add_f32 v204, v200, v204
  v_mfma_f32_16x16x32_bf16 a[8:11], a[232:235], v[112:115], a[8:11]
  buffer_load_dwordx4 v243, s[36:39], s74 offen offset:1024 lds
  v_exp_f32 v192, v56
  v_mfma_f32_16x16x32_bf16 a[40:43], a[232:235], v[116:119], a[40:43]
  ds_read_b64_tr_b16 a[164:165], v253 offset:25376
  v_add_f32 v202, v199, v202
  v_cvt_pk_bf16_f32 v123, v198, v199
  v_mfma_f32_16x16x32_bf16 a[12:15], a[236:239], v[112:115], a[12:15]
  v_exp_f32 v193, v57
  v_mfma_f32_16x16x32_bf16 a[44:47], a[236:239], v[116:119], a[44:47]
  ds_read_b64_tr_b16 a[166:167], v253 offset:25632
  v_add_f32 v205, v201, v205
  v_mfma_f32_16x16x32_bf16 a[16:19], a[240:243], v[112:115], a[16:19]
  v_exp_f32 v194, v58
  v_mfma_f32_16x16x32_bf16 a[48:51], a[240:243], v[116:119], a[48:51]
  ds_read_b64_tr_b16 a[168:169], v253 offset:25408
  v_add_f32 v203, v192, v193
  v_cvt_pk_bf16_f32 v124, v192, v193
  v_mfma_f32_16x16x32_bf16 a[20:23], a[244:247], v[112:115], a[20:23]
  v_exp_f32 v195, v59
  v_mfma_f32_16x16x32_bf16 a[52:55], a[244:247], v[116:119], a[52:55]
  ds_read_b64_tr_b16 a[170:171], v253 offset:25664
  v_add_f32 v203, v194, v203
  v_mfma_f32_16x16x32_bf16 a[24:27], a[248:251], v[112:115], a[24:27]
  v_exp_f32 v196, v60
  v_mfma_f32_16x16x32_bf16 a[56:59], a[248:251], v[116:119], a[56:59]
  ds_read_b64_tr_b16 a[172:173], v253 offset:25440
  v_add_f32 v203, v195, v203
  v_cvt_pk_bf16_f32 v125, v194, v195
  v_mfma_f32_16x16x32_bf16 a[28:31], a[252:255], v[112:115], a[28:31]
  v_exp_f32 v197, v61
  v_mfma_f32_16x16x32_bf16 a[60:63], a[252:255], v[116:119], a[60:63]
  ds_read_b64_tr_b16 a[174:175], v253 offset:25696
  v_add_f32 v203, v196, v203
  v_mfma_f32_16x16x32_bf16 v[80:83], a[192:195], v[160:163], v[104:107]
  s_add_u32 m0, s73, 8448
  v_exp_f32 v198, v62
  v_mfma_f32_16x16x32_bf16 v[80:83], a[196:199], v[164:167], v[80:83]
  ds_read_b64_tr_b16 a[176:177], v253 offset:25472
  v_add_f32 v203, v197, v203
  v_cvt_pk_bf16_f32 v126, v196, v197
  v_mfma_f32_16x16x32_bf16 v[80:83], a[200:203], v[168:171], v[80:83]
  buffer_load_dwordx4 v244, s[36:39], s74 offen offset:0 lds
  v_exp_f32 v199, v63
  v_mfma_f32_16x16x32_bf16 v[80:83], a[204:207], v[172:175], v[80:83]
  ds_read_b64_tr_b16 a[178:179], v253 offset:25728
  v_add_f32 v203, v198, v203
  v_mfma_f32_16x16x32_bf16 v[84:87], a[208:211], v[160:163], v[104:107]
  v_exp_f32 v192, v64
  v_mfma_f32_16x16x32_bf16 v[84:87], a[212:215], v[164:167], v[84:87]
  ds_read_b64_tr_b16 a[180:181], v253 offset:25504
  v_add_f32 v203, v199, v203
  v_cvt_pk_bf16_f32 v127, v198, v199
  v_mfma_f32_16x16x32_bf16 v[84:87], a[216:219], v[168:171], v[84:87]
  v_exp_f32 v193, v65
  v_mfma_f32_16x16x32_bf16 v[84:87], a[220:223], v[172:175], v[84:87]
  ds_read_b64_tr_b16 a[182:183], v253 offset:25760
  v_max_f32 v209, v202, v203
  v_mfma_f32_16x16x32_bf16 v[88:91], a[192:195], v[176:179], v[108:111]
  v_exp_f32 v194, v66
  v_mfma_f32_16x16x32_bf16 v[88:91], a[196:199], v[180:183], v[88:91]
  ds_read_b64_tr_b16 a[184:185], v253 offset:25536
  v_add_f32 v200, v192, v193
  v_cvt_pk_bf16_f32 v112, v192, v193
  v_mfma_f32_16x16x32_bf16 v[88:91], a[200:203], v[184:187], v[88:91]
  v_exp_f32 v195, v67
  v_mfma_f32_16x16x32_bf16 v[88:91], a[204:207], v[188:191], v[88:91]
  ds_read_b64_tr_b16 a[186:187], v253 offset:25792
  v_cmp_gt_f32 vcc, v209, v208
  v_add_f32 v200, v194, v200
  v_mfma_f32_16x16x32_bf16 v[92:95], a[208:211], v[176:179], v[108:111]
  v_exp_f32 v196, v68
  v_mfma_f32_16x16x32_bf16 v[92:95], a[212:215], v[180:183], v[92:95]
  ds_read_b64_tr_b16 a[188:189], v253 offset:25568
  v_add_f32 v200, v195, v200
  v_cvt_pk_bf16_f32 v113, v194, v195
  v_mfma_f32_16x16x32_bf16 v[92:95], a[216:219], v[184:187], v[92:95]
  v_exp_f32 v197, v69
  v_mfma_f32_16x16x32_bf16 v[92:95], a[220:223], v[188:191], v[92:95]
  ds_read_b64_tr_b16 a[190:191], v253 offset:25824
  s_cbranch_vccnz KA_R00
KA_R00B:
  v_add_f32 v200, v196, v200
  v_mfma_f32_16x16x32_bf16 a[64:67], a[224:227], v[120:123], a[64:67]
  buffer_load_dwordx4 v244, s[36:39], s74 offen offset:1024 lds
  v_exp_f32 v198, v70
  v_mfma_f32_16x16x32_bf16 a[96:99], a[224:227], v[124:127], a[96:99]
  v_add_f32 v200, v197, v200
  v_cvt_pk_bf16_f32 v114, v196, v197
  v_mfma_f32_16x16x32_bf16 a[68:71], a[228:231], v[120:123], a[68:71]
  v_exp_f32 v199, v71
  v_mfma_f32_16x16x32_bf16 a[100:103], a[228:231], v[124:127], a[100:103]
  v_add_f32 v206, v202, v206
  v_add_f32 v200, v198, v200
  v_mfma_f32_16x16x32_bf16 a[72:75], a[232:235], v[120:123], a[72:75]
  v_exp_f32 v192, v72
  v_mfma_f32_16x16x32_bf16 a[104:107], a[232:235], v[124:127], a[104:107]
  v_add_f32 v200, v199, v200
  v_cvt_pk_bf16_f32 v115, v198, v199
  v_mfma_f32_16x16x32_bf16 a[76:79], a[236:239], v[120:123], a[76:79]
  v_exp_f32 v193, v73
  v_mfma_f32_16x16x32_bf16 a[108:111], a[236:239], v[124:127], a[108:111]
  v_add_f32 v207, v203, v207
  v_mfma_f32_16x16x32_bf16 a[80:83], a[240:243], v[120:123], a[80:83]
  v_exp_f32 v194, v74
  v_mfma_f32_16x16x32_bf16 a[112:115], a[240:243], v[124:127], a[112:115]
  v_add_f32 v201, v192, v193
  v_cvt_pk_bf16_f32 v116, v192, v193
  v_mfma_f32_16x16x32_bf16 a[84:87], a[244:247], v[120:123], a[84:87]
  v_exp_f32 v195, v75
  v_mfma_f32_16x16x32_bf16 a[116:119], a[244:247], v[124:127], a[116:119]
  v_add_f32 v201, v194, v201
  v_mfma_f32_16x16x32_bf16 a[88:91], a[248:251], v[120:123], a[88:91]
  s_add_u32 m0, s73, 25344
  v_exp_f32 v196, v76
  v_mfma_f32_16x16x32_bf16 a[120:123], a[248:251], v[124:127], a[120:123]
  v_add_f32 v201, v195, v201
  v_cvt_pk_bf16_f32 v117, v194, v195
  v_mfma_f32_16x16x32_bf16 a[92:95], a[252:255], v[120:123], a[92:95]
  s_waitcnt lgkmcnt(0)
  buffer_load_dwordx4 v245, s[40:43], s74 offen offset:0 lds
  v_exp_f32 v197, v77
  v_mfma_f32_16x16x32_bf16 a[124:127], a[252:255], v[124:127], a[124:127]
  v_add_f32 v201, v196, v201
  v_mfma_f32_16x16x32_bf16 v[32:35], a[128:131], v[128:131], v[96:99]
  v_exp_f32 v198, v78
  v_mfma_f32_16x16x32_bf16 v[32:35], a[132:135], v[132:135], v[32:35]
  ds_read_b128 a[192:195], v252 offset:8448
  v_add_f32 v201, v197, v201
  v_cvt_pk_bf16_f32 v118, v196, v197
  v_mfma_f32_16x16x32_bf16 v[32:35], a[136:139], v[136:139], v[32:35]
  v_exp_f32 v199, v79
  v_mfma_f32_16x16x32_bf16 v[32:35], a[140:143], v[140:143], v[32:35]
  ds_read_b128 a[196:199], v252 offset:8512
  v_add_f32 v201, v198, v201
  v_mfma_f32_16x16x32_bf16 v[36:39], a[144:147], v[128:131], v[96:99]
  v_exp_f32 v192, v80
  v_mfma_f32_16x16x32_bf16 v[36:39], a[148:151], v[132:135], v[36:39]
  ds_read_b128 a[200:203], v252 offset:8576
  v_add_f32 v201, v199, v201
  v_cvt_pk_bf16_f32 v119, v198, v199
  v_mfma_f32_16x16x32_bf16 v[36:39], a[152:155], v[136:139], v[36:39]
  v_exp_f32 v193, v81
  v_mfma_f32_16x16x32_bf16 v[36:39], a[156:159], v[140:143], v[36:39]
  ds_read_b128 a[204:207], v252 offset:8640
  v_max_f32 v209, v200, v201
  v_mfma_f32_16x16x32_bf16 v[40:43], a[128:131], v[144:147], v[100:103]
  v_exp_f32 v194, v82
  v_mfma_f32_16x16x32_bf16 v[40:43], a[132:135], v[148:151], v[40:43]
  ds_read_b128 a[208:211], v252 offset:9472
  v_add_f32 v202, v192, v193
  v_cvt_pk_bf16_f32 v120, v192, v193
  v_mfma_f32_16x16x32_bf16 v[40:43], a[136:139], v[152:155], v[40:43]
  s_add_u32 m0, s73, 26144
  v_exp_f32 v195, v83
  v_mfma_f32_16x16x32_bf16 v[40:43], a[140:143], v[156:159], v[40:43]
  ds_read_b128 a[212:215], v252 offset:9536
  v_cmp_gt_f32 vcc, v209, v208
  v_add_f32 v202, v194, v202
  v_mfma_f32_16x16x32_bf16 v[44:47], a[144:147], v[144:147], v[100:103]
  buffer_load_dwordx4 v245, s[40:43], s74 offen offset:256 lds
  v_exp_f32 v196, v84
  v_mfma_f32_16x16x32_bf16 v[44:47], a[148:151], v[148:151], v[44:47]
  ds_read_b128 a[216:219], v252 offset:9600
  v_add_f32 v202, v195, v202
  v_cvt_pk_bf16_f32 v121, v194, v195
  v_mfma_f32_16x16x32_bf16 v[44:47], a[152:155], v[152:155], v[44:47]
  v_exp_f32 v197, v85
  v_mfma_f32_16x16x32_bf16 v[44:47], a[156:159], v[156:159], v[44:47]
  ds_read_b128 a[220:223], v252 offset:9664
  s_cbranch_vccnz KA_R01
KA_R01B:
  v_add_f32 v202, v196, v202
  v_mfma_f32_16x16x32_bf16 a[0:3], a[160:163], v[112:115], a[0:3]
  v_exp_f32 v198, v86
  v_mfma_f32_16x16x32_bf16 a[32:35], a[160:163], v[116:119], a[32:35]
  ds_read_b64_tr_b16 a[224:225], v253 offset:16896
  v_add_f32 v202, v197, v202
  v_cvt_pk_bf16_f32 v122, v196, v197
  v_mfma_f32_16x16x32_bf16 a[4:7], a[164:167], v[112:115], a[4:7]
  v_exp_f32 v199, v87
  v_mfma_f32_16x16x32_bf16 a[36:39], a[164:167], v[116:119], a[36:39]
  ds_read_b64_tr_b16 a[226:227], v253 offset:17152
  v_add_f32 v204, v200, v204
  v_add_f32 v202, v198, v202
  v_mfma_f32_16x16x32_bf16 a[8:11], a[168:171], v[112:115], a[8:11]
  v_exp_f32 v192, v88
  v_mfma_f32_16x16x32_bf16 a[40:43], a[168:171], v[116:119], a[40:43]
  ds_read_b64_tr_b16 a[228:229], v253 offset:16928
  v_add_f32 v202, v199, v202
  v_cvt_pk_bf16_f32 v123, v198, v199
  v_mfma_f32_16x16x32_bf16 a[12:15], a[172:175], v[112:115], a[12:15]
  v_exp_f32 v193, v89
  v_mfma_f32_16x16x32_bf16 a[44:47], a[172:175], v[116:119], a[44:47]
  ds_read_b64_tr_b16 a[230:231], v253 offset:17184
  v_add_f32 v205, v201, v205
  v_mfma_f32_16x16x32_bf16 a[16:19], a[176:179], v[112:115], a[16:19]
  s_add_u32 m0, s73, 16896
  v_exp_f32 v194, v90
  v_mfma_f32_16x16x32_bf16 a[48:51], a[176:179], v[116:119], a[48:51]
  ds_read_b64_tr_b16 a[232:233], v253 offset:16960
  v_add_f32 v203, v192, v193
  v_cvt_pk_bf16_f32 v124, v192, v193
  v_mfma_f32_16x16x32_bf16 a[20:23], a[180:183], v[112:115], a[20:23]
  buffer_load_dwordx4 v246, s[40:43], s74 offen offset:0 lds
  v_exp_f32 v195, v91
  v_mfma_f32_16x16x32_bf16 a[52:55], a[180:183], v[116:119], a[52:55]
  ds_read_b64_tr_b16 a[234:235], v253 offset:17216
  v_add_f32 v203, v194, v203
  v_mfma_f32_16x16x32_bf16 a[24:27], a[184:187], v[112:115], a[24:27]
  v_exp_f32 v196, v92
  v_mfma_f32_16x16x32_bf16 a[56:59], a[184:187], v[116:119], a[56:59]
  ds_read_b64_tr_b16 a[236:237], v253 offset:16992
  v_add_f32 v203, v195, v203
  v_cvt_pk_bf16_f32 v125, v194, v195
  v_mfma_f32_16x16x32_bf16 a[28:31], a[188:191], v[112:115], a[28:31]
  v_exp_f32 v197, v93
  v_mfma_f32_16x16x32_bf16 a[60:63], a[188:191], v[116:119], a[60:63]
  ds_read_b64_tr_b16 a[238:239], v253 offset:17248
  v_add_f32 v203, v196, v203
  v_mfma_f32_16x16x32_bf16 v[48:51], a[128:131], v[160:163], v[104:107]
  v_exp_f32 v198, v94
  v_mfma_f32_16x16x32_bf16 v[48:51], a[132:135], v[164:167], v[48:51]
  ds_read_b64_tr_b16 a[240:241], v253 offset:17024
  v_add_f32 v203, v197, v203
  v_cvt_pk_bf16_f32 v126, v196, v197
  v_mfma_f32_16x16x32_bf16 v[48:51], a[136:139], v[168:171], v[48:51]
  v_exp_f32 v199, v95
  v_mfma_f32_16x16x32_bf16 v[48:51], a[140:143], v[172:175], v[48:51]
  ds_read_b64_tr_b16 a[242:243], v253 offset:17280
  v_add_f32 v203, v198, v203
  v_mfma_f32_16x16x32_bf16 v[52:55], a[144:147], v[160:163], v[104:107]
  v_exp_f32 v192, v32
  v_mfma_f32_16x16x32_bf16 v[52:55], a[148:151], v[164:167], v[52:55]
  ds_read_b64_tr_b16 a[244:245], v253 offset:17056
  v_add_f32 v203, v199, v203
  v_cvt_pk_bf16_f32 v127, v198, v199
  v_mfma_f32_16x16x32_bf16 v[52:55], a[152:155], v[168:171], v[52:55]
  s_add_u32 m0, s73, 17696
  v_exp_f32 v193, v33
  v_mfma_f32_16x16x32_bf16 v[52:55], a[156:159], v[172:175], v[52:55]
  ds_read_b64_tr_b16 a[246:247], v253 offset:17312
  v_max_f32 v209, v202, v203
  v_mfma_f32_16x16x32_bf16 v[56:59], a[128:131], v[176:179], v[108:111]
  buffer_load_dwordx4 v246, s[40:43], s74 offen offset:256 lds
  v_exp_f32 v194, v34
  v_mfma_f32_16x16x32_bf16 v[56:59], a[132:135], v[180:183], v[56:59]
  ds_read_b64_tr_b16 a[248:249], v253 offset:17088
  v_add_f32 v200, v192, v193
  v_cvt_pk_bf16_f32 v112, v192, v193
  v_mfma_f32_16x16x32_bf16 v[56:59], a[136:139], v[184:187], v[56:59]
  v_exp_f32 v195, v35
  v_mfma_f32_16x16x32_bf16 v[56:59], a[140:143], v[188:191], v[56:59]
  ds_read_b64_tr_b16 a[250:251], v253 offset:17344
  v_cmp_gt_f32 vcc, v209, v208
  v_add_f32 v200, v194, v200
  v_mfma_f32_16x16x32_bf16 v[60:63], a[144:147], v[176:179], v[108:111]
  s_add_u32 s74, s74, 16384
  v_exp_f32 v196, v36
  v_mfma_f32_16x16x32_bf16 v[60:63], a[148:151], v[180:183], v[60:63]
  ds_read_b64_tr_b16 a[252:253], v253 offset:17120
  v_add_f32 v200, v195, v200
  v_cvt_pk_bf16_f32 v113, v194, v195
  v_mfma_f32_16x16x32_bf16 v[60:63], a[152:155], v[184:187], v[60:63]
  s_add_u32 s73, s73, 33792
  v_exp_f32 v197, v37
  v_mfma_f32_16x16x32_bf16 v[60:63], a[156:159], v[188:191], v[60:63]
  ds_read_b64_tr_b16 a[254:255], v253 offset:17376
  s_cbranch_vccnz KA_R10
KA_R10B:
  v_add_f32 v200, v196, v200
  v_mfma_f32_16x16x32_bf16 a[64:67], a[160:163], v[120:123], a[64:67]
  s_cmp_ge_u32 s73, s76
  v_exp_f32 v198, v38
  v_mfma_f32_16x16x32_bf16 a[96:99], a[160:163], v[124:127], a[96:99]
  v_add_f32 v200, v197, v200
  v_cvt_pk_bf16_f32 v114, v196, v197
  v_mfma_f32_16x16x32_bf16 a[68:71], a[164:167], v[120:123], a[68:71]
  s_cselect_b32 s73, s61, s73
  v_exp_f32 v199, v39
  v_mfma_f32_16x16x32_bf16 a[100:103], a[164:167], v[124:127], a[100:103]
  v_add_f32 v206, v202, v206
  v_add_f32 v200, v198, v200
  v_mfma_f32_16x16x32_bf16 a[72:75], a[168:171], v[120:123], a[72:75]
  s_add_u32 s72, s72, 33792
  v_exp_f32 v192, v40
  v_mfma_f32_16x16x32_bf16 a[104:107], a[168:171], v[124:127], a[104:107]
  v_add_f32 v200, v199, v200
  v_cvt_pk_bf16_f32 v115, v198, v199
  v_mfma_f32_16x16x32_bf16 a[76:79], a[172:175], v[120:123], a[76:79]
  s_cmp_ge_u32 s72, 135168
  v_exp_f32 v193, v41
  v_mfma_f32_16x16x32_bf16 a[108:111], a[172:175], v[124:127], a[108:111]
  v_add_f32 v207, v203, v207
  v_mfma_f32_16x16x32_bf16 a[80:83], a[176:179], v[120:123], a[80:83]
  s_cselect_b32 s72, 0, s72
  v_exp_f32 v194, v42
  v_mfma_f32_16x16x32_bf16 a[112:115], a[176:179], v[124:127], a[112:115]
  v_add_f32 v201, v192, v193
  v_cvt_pk_bf16_f32 v116, v192, v193
  v_mfma_f32_16x16x32_bf16 a[84:87], a[180:183], v[120:123], a[84:87]
  s_add_u32 s75, s75, 1
  v_exp_f32 v195, v43
  v_mfma_f32_16x16x32_bf16 a[116:119], a[180:183], v[124:127], a[116:119]
  v_add_f32 v201, v194, v201
  v_mfma_f32_16x16x32_bf16 a[88:91], a[184:187], v[120:123], a[88:91]
  s_waitcnt vmcnt(16)
  v_exp_f32 v196, v44
  v_mfma_f32_16x16x32_bf16 a[120:123], a[184:187], v[124:127], a[120:123]
  v_add_f32 v201, v195, v201
  v_cvt_pk_bf16_f32 v117, v194, v195
  v_add_u32 v252, s72, v247
  v_mfma_f32_16x16x32_bf16 a[92:95], a[188:191], v[120:123], a[92:95]
  s_waitcnt lgkmcnt(0)
  s_cmp_lt_u32 s75, 32
  v_exp_f32 v197, v45
  v_mfma_f32_16x16x32_bf16 a[124:127], a[188:191], v[124:127], a[124:127]
  v_add_f32 v201, v196, v201
  v_add_u32 v253, s72, v248
  s_barrier
  s_cbranch_scc1 KA_LOOP2
  s_nop 7
  v_mov_b32 v0, v204
  s_nop 1
  v_permlane32_swap_b32 v204, v0
  s_nop 1
  v_add_f32 v204, v204, v0
  v_mov_b32 v0, v204
  s_nop 1
  v_permlane16_swap_b32 v204, v0
  s_nop 1
  v_add_f32 v204, v204, v0
  v_rcp_f32 v204, v204
  v_mov_b32 v0, v205
  s_nop 1
  v_permlane32_swap_b32 v205, v0
  s_nop 1
  v_add_f32 v205, v205, v0
  v_mov_b32 v0, v205
  s_nop 1
  v_permlane16_swap_b32 v205, v0
  s_nop 1
  v_add_f32 v205, v205, v0
  v_rcp_f32 v205, v205
  v_mov_b32 v0, v206
  s_nop 1
  v_permlane32_swap_b32 v206, v0
  s_nop 1
  v_add_f32 v206, v206, v0
  v_mov_b32 v0, v206
  s_nop 1
  v_permlane16_swap_b32 v206, v0
  s_nop 1
  v_add_f32 v206, v206, v0
  v_rcp_f32 v206, v206
  v_mov_b32 v0, v207
  s_nop 1
  v_permlane32_swap_b32 v207, v0
  s_nop 1
  v_add_f32 v207, v207, v0
  v_mov_b32 v0, v207
  s_nop 1
  v_permlane16_swap_b32 v207, v0
  s_nop 1
  v_add_f32 v207, v207, v0
  v_rcp_f32 v207, v207
  s_mov_b64 s[84:85], 0
  s_branch KA_FIN
KA_R00:
  s_nop 15
  v_max3_f32 v0, v48, v49, v50
  v_max3_f32 v0, v0, v51, v52
  v_max3_f32 v0, v0, v53, v54
  v_max3_f32 v0, v0, v55, 0
  v_mov_b32 v1, v0
  s_nop 1
  v_permlane32_swap_b32 v0, v1
  s_nop 1
  v_max_f32 v0, v0, v1
  v_mov_b32 v1, v0
  s_nop 1
  v_permlane16_swap_b32 v0, v1
  s_nop 1
  v_max_f32 v0, v0, v1
  v_exp_f32 v1, -v0
  v_sub_f32 v104, v104, v0
  v_sub_f32 v105, v105, v0
  v_sub_f32 v106, v106, v0
  v_sub_f32 v107, v107, v0
  v_sub_f32 v48, v48, v0
  v_sub_f32 v49, v49, v0
  v_sub_f32 v50, v50, v0
  v_sub_f32 v51, v51, v0
  v_sub_f32 v52, v52, v0
  v_sub_f32 v53, v53, v0
  v_sub_f32 v54, v54, v0
  v_sub_f32 v55, v55, v0
  v_sub_f32 v80, v80, v0
  v_sub_f32 v81, v81, v0
  v_sub_f32 v82, v82, v0
  v_sub_f32 v83, v83, v0
  v_sub_f32 v84, v84, v0
  v_sub_f32 v85, v85, v0
  v_sub_f32 v86, v86, v0
  v_sub_f32 v87, v87, v0
  v_mul_f32 v206, v206, v1
  v_accvgpr_read_b32 v2, a64
  v_accvgpr_read_b32 v3, a65
  v_accvgpr_read_b32 v4, a66
  v_accvgpr_read_b32 v5, a67
  v_mul_f32 v2, v2, v1
  v_mul_f32 v3, v3, v1
  v_mul_f32 v4, v4, v1
  v_mul_f32 v5, v5, v1
  v_accvgpr_write_b32 a64, v2
  v_accvgpr_write_b32 a65, v3
  v_accvgpr_write_b32 a66, v4
  v_accvgpr_write_b32 a67, v5
  v_accvgpr_read_b32 v2, a68
  v_accvgpr_read_b32 v3, a69
  v_accvgpr_read_b32 v4, a70
  v_accvgpr_read_b32 v5, a71
  v_mul_f32 v2, v2, v1
  v_mul_f32 v3, v3, v1
  v_mul_f32 v4, v4, v1
  v_mul_f32 v5, v5, v1
  v_accvgpr_write_b32 a68, v2
  v_accvgpr_write_b32 a69, v3
  v_accvgpr_write_b32 a70, v4
  v_accvgpr_write_b32 a71, v5
  v_accvgpr_read_b32 v2, a72
  v_accvgpr_read_b32 v3, a73
  v_accvgpr_read_b32 v4, a74
  v_accvgpr_read_b32 v5, a75
  v_mul_f32 v2, v2, v1
  v_mul_f32 v3, v3, v1
  v_mul_f32 v4, v4, v1
  v_mul_f32 v5, v5, v1
  v_accvgpr_write_b32 a72, v2
  v_accvgpr_write_b32 a73, v3
  v_accvgpr_write_b32 a74, v4
  v_accvgpr_write_b32 a75, v5
  v_accvgpr_read_b32 v2, a76
  v_accvgpr_read_b32 v3, a77
  v_accvgpr_read_b32 v4, a78
  v_accvgpr_read_b32 v5, a79
  v_mul_f32 v2, v2, v1
  v_mul_f32 v3, v3, v1
  v_mul_f32 v4, v4, v1
  v_mul_f32 v5, v5, v1
  v_accvgpr_write_b32 a76, v2
  v_accvgpr_write_b32 a77, v3
  v_accvgpr_write_b32 a78, v4
  v_accvgpr_write_b32 a79, v5
  v_accvgpr_read_b32 v2, a80
  v_accvgpr_read_b32 v3, a81
  v_accvgpr_read_b32 v4, a82
  v_accvgpr_read_b32 v5, a83
  v_mul_f32 v2, v2, v1
  v_mul_f32 v3, v3, v1
  v_mul_f32 v4, v4, v1
  v_mul_f32 v5, v5, v1
  v_accvgpr_write_b32 a80, v2
  v_accvgpr_write_b32 a81, v3
  v_accvgpr_write_b32 a82, v4
  v_accvgpr_write_b32 a83, v5
  v_accvgpr_read_b32 v2, a84
  v_accvgpr_read_b32 v3, a85
  v_accvgpr_read_b32 v4, a86
  v_accvgpr_read_b32 v5, a87
  v_mul_f32 v2, v2, v1
  v_mul_f32 v3, v3, v1
  v_mul_f32 v4, v4, v1
  v_mul_f32 v5, v5, v1
  v_accvgpr_write_b32 a84, v2
  v_accvgpr_write_b32 a85, v3
  v_accvgpr_write_b32 a86, v4
  v_accvgpr_write_b32 a87, v5
  v_accvgpr_read_b32 v2, a88
  v_accvgpr_read_b32 v3, a89
  v_accvgpr_read_b32 v4, a90
  v_accvgpr_read_b32 v5, a91
  v_mul_f32 v2, v2, v1
  v_mul_f32 v3, v3, v1
  v_mul_f32 v4, v4, v1
  v_mul_f32 v5, v5, v1
  v_accvgpr_write_b32 a88, v2
  v_accvgpr_write_b32 a89, v3
  v_accvgpr_write_b32 a90, v4
  v_accvgpr_write_b32 a91, v5
  v_accvgpr_read_b32 v2, a92
  v_accvgpr_read_b32 v3, a93
  v_accvgpr_read_b32 v4, a94
  v_accvgpr_read_b32 v5, a95
  v_mul_f32 v2, v2, v1
  v_mul_f32 v3, v3, v1
  v_mul_f32 v4, v4, v1
  v_mul_f32 v5, v5, v1
  v_accvgpr_write_b32 a92, v2
  v_accvgpr_write_b32 a93, v3
  v_accvgpr_write_b32 a94, v4
  v_accvgpr_write_b32 a95, v5
  v_exp_f32 v2, v48
  v_exp_f32 v3, v49
  v_exp_f32 v4, v50
  v_exp_f32 v5, v51
  v_exp_f32 v6, v52
  v_exp_f32 v7, v53
  v_exp_f32 v8, v54
  v_exp_f32 v9, v55
  s_nop 0
  v_add_f32 v202, v2, v3
  v_add_f32 v202, v202, v4
  v_add_f32 v202, v202, v5
  v_add_f32 v202, v202, v6
  v_add_f32 v202, v202, v7
  v_add_f32 v202, v202, v8
  v_add_f32 v202, v202, v9
  v_cvt_pk_bf16_f32 v120, v2, v3
  v_cvt_pk_bf16_f32 v121, v4, v5
  v_cvt_pk_bf16_f32 v122, v6, v7
  v_cvt_pk_bf16_f32 v123, v8, v9
  v_max3_f32 v0, v56, v57, v58
  v_max3_f32 v0, v0, v59, v60
  v_max3_f32 v0, v0, v61, v62
  v_max3_f32 v0, v0, v63, 0
  v_mov_b32 v1, v0
  s_nop 1
  v_permlane32_swap_b32 v0, v1
  s_nop 1
  v_max_f32 v0, v0, v1
  v_mov_b32 v1, v0
  s_nop 1
  v_permlane16_swap_b32 v0, v1
  s_nop 1
  v_max_f32 v0, v0, v1
  v_exp_f32 v1, -v0
  v_sub_f32 v108, v108, v0
  v_sub_f32 v109, v109, v0
  v_sub_f32 v110, v110, v0
  v_sub_f32 v111, v111, v0
  v_sub_f32 v56, v56, v0
  v_sub_f32 v57, v57, v0
  v_sub_f32 v58, v58, v0
  v_sub_f32 v59, v59, v0
  v_sub_f32 v60, v60, v0
  v_sub_f32 v61, v61, v0
  v_sub_f32 v62, v62, v0
  v_sub_f32 v63, v63, v0
  v_sub_f32 v88, v88, v0
  v_sub_f32 v89, v89, v0
  v_sub_f32 v90, v90, v0
  v_sub_f32 v91, v91, v0
  v_sub_f32 v92, v92, v0
  v_sub_f32 v93, v93, v0
  v_sub_f32 v94, v94, v0
  v_sub_f32 v95, v95, v0
  v_mul_f32 v207, v207, v1
  v_accvgpr_read_b32 v2, a96
  v_accvgpr_read_b32 v3, a97
  v_accvgpr_read_b32 v4, a98
  v_accvgpr_read_b32 v5, a99
  v_mul_f32 v2, v2, v1
  v_mul_f32 v3, v3, v1
  v_mul_f32 v4, v4, v1
  v_mul_f32 v5, v5, v1
  v_accvgpr_write_b32 a96, v2
  v_accvgpr_write_b32 a97, v3
  v_accvgpr_write_b32 a98, v4
  v_accvgpr_write_b32 a99, v5
  v_accvgpr_read_b32 v2, a100
  v_accvgpr_read_b32 v3, a101
  v_accvgpr_read_b32 v4, a102
  v_accvgpr_read_b32 v5, a103
  v_mul_f32 v2, v2, v1
  v_mul_f32 v3, v3, v1
  v_mul_f32 v4, v4, v1
  v_mul_f32 v5, v5, v1
  v_accvgpr_write_b32 a100, v2
  v_accvgpr_write_b32 a101, v3
  v_accvgpr_write_b32 a102, v4
  v_accvgpr_write_b32 a103, v5
  v_accvgpr_read_b32 v2, a104
  v_accvgpr_read_b32 v3, a105
  v_accvgpr_read_b32 v4, a106
  v_accvgpr_read_b32 v5, a107
  v_mul_f32 v2, v2, v1
  v_mul_f32 v3, v3, v1
  v_mul_f32 v4, v4, v1
  v_mul_f32 v5, v5, v1
  v_accvgpr_write_b32 a104, v2
  v_accvgpr_write_b32 a105, v3
  v_accvgpr_write_b32 a106, v4
  v_accvgpr_write_b32 a107, v5
  v_accvgpr_read_b32 v2, a108
  v_accvgpr_read_b32 v3, a109
  v_accvgpr_read_b32 v4, a110
  v_accvgpr_read_b32 v5, a111
  v_mul_f32 v2, v2, v1
  v_mul_f32 v3, v3, v1
  v_mul_f32 v4, v4, v1
  v_mul_f32 v5, v5, v1
  v_accvgpr_write_b32 a108, v2
  v_accvgpr_write_b32 a109, v3
  v_accvgpr_write_b32 a110, v4
  v_accvgpr_write_b32 a111, v5
  v_accvgpr_read_b32 v2, a112
  v_accvgpr_read_b32 v3, a113
  v_accvgpr_read_b32 v4, a114
  v_accvgpr_read_b32 v5, a115
  v_mul_f32 v2, v2, v1
  v_mul_f32 v3, v3, v1
  v_mul_f32 v4, v4, v1
  v_mul_f32 v5, v5, v1
  v_accvgpr_write_b32 a112, v2
  v_accvgpr_write_b32 a113, v3
  v_accvgpr_write_b32 a114, v4
  v_accvgpr_write_b32 a115, v5
  v_accvgpr_read_b32 v2, a116
  v_accvgpr_read_b32 v3, a117
  v_accvgpr_read_b32 v4, a118
  v_accvgpr_read_b32 v5, a119
  v_mul_f32 v2, v2, v1
  v_mul_f32 v3, v3, v1
  v_mul_f32 v4, v4, v1
  v_mul_f32 v5, v5, v1
  v_accvgpr_write_b32 a116, v2
  v_accvgpr_write_b32 a117, v3
  v_accvgpr_write_b32 a118, v4
  v_accvgpr_write_b32 a119, v5
  v_accvgpr_read_b32 v2, a120
  v_accvgpr_read_b32 v3, a121
  v_accvgpr_read_b32 v4, a122
  v_accvgpr_read_b32 v5, a123
  v_mul_f32 v2, v2, v1
  v_mul_f32 v3, v3, v1
  v_mul_f32 v4, v4, v1
  v_mul_f32 v5, v5, v1
  v_accvgpr_write_b32 a120, v2
  v_accvgpr_write_b32 a121, v3
  v_accvgpr_write_b32 a122, v4
  v_accvgpr_write_b32 a123, v5
  v_accvgpr_read_b32 v2, a124
  v_accvgpr_read_b32 v3, a125
  v_accvgpr_read_b32 v4, a126
  v_accvgpr_read_b32 v5, a127
  v_mul_f32 v2, v2, v1
  v_mul_f32 v3, v3, v1
  v_mul_f32 v4, v4, v1
  v_mul_f32 v5, v5, v1
  v_accvgpr_write_b32 a124, v2
  v_accvgpr_write_b32 a125, v3
  v_accvgpr_write_b32 a126, v4
  v_accvgpr_write_b32 a127, v5
  v_exp_f32 v2, v56
  v_exp_f32 v3, v57
  v_exp_f32 v4, v58
  v_exp_f32 v5, v59
  v_exp_f32 v6, v60
  v_exp_f32 v7, v61
  v_exp_f32 v8, v62
  v_exp_f32 v9, v63
  s_nop 0
  v_add_f32 v203, v2, v3
  v_add_f32 v203, v203, v4
  v_add_f32 v203, v203, v5
  v_add_f32 v203, v203, v6
  v_add_f32 v203, v203, v7
  v_add_f32 v203, v203, v8
  v_add_f32 v203, v203, v9
  v_cvt_pk_bf16_f32 v124, v2, v3
  v_cvt_pk_bf16_f32 v125, v4, v5
  v_cvt_pk_bf16_f32 v126, v6, v7
  v_cvt_pk_bf16_f32 v127, v8, v9
  s_nop 3
  s_branch KA_R00B
KA_R01:
  s_nop 15
  v_max3_f32 v0, v64, v65, v66
  v_max3_f32 v0, v0, v67, v68
  v_max3_f32 v0, v0, v69, v70
  v_max3_f32 v0, v0, v71, 0
  v_mov_b32 v1, v0
  s_nop 1
  v_permlane32_swap_b32 v0, v1
  s_nop 1
  v_max_f32 v0, v0, v1
  v_mov_b32 v1, v0
  s_nop 1
  v_permlane16_swap_b32 v0, v1
  s_nop 1
  v_max_f32 v0, v0, v1
  v_exp_f32 v1, -v0
  v_sub_f32 v96, v96, v0
  v_sub_f32 v97, v97, v0
  v_sub_f32 v98, v98, v0
  v_sub_f32 v99, v99, v0
  v_sub_f32 v64, v64, v0
  v_sub_f32 v65, v65, v0
  v_sub_f32 v66, v66, v0
  v_sub_f32 v67, v67, v0
  v_sub_f32 v68, v68, v0
  v_sub_f32 v69, v69, v0
  v_sub_f32 v70, v70, v0
  v_sub_f32 v71, v71, v0
  v_sub_f32 v32, v32, v0
  v_sub_f32 v33, v33, v0
  v_sub_f32 v34, v34, v0
  v_sub_f32 v35, v35, v0
  v_sub_f32 v36, v36, v0
  v_sub_f32 v37, v37, v0
  v_sub_f32 v38, v38, v0
  v_sub_f32 v39, v39, v0
  v_mul_f32 v204, v204, v1
  v_accvgpr_read_b32 v2, a0
  v_accvgpr_read_b32 v3, a1
  v_accvgpr_read_b32 v4, a2
  v_accvgpr_read_b32 v5, a3
  v_mul_f32 v2, v2, v1
  v_mul_f32 v3, v3, v1
  v_mul_f32 v4, v4, v1
  v_mul_f32 v5, v5, v1
  v_accvgpr_write_b32 a0, v2
  v_accvgpr_write_b32 a1, v3
  v_accvgpr_write_b32 a2, v4
  v_accvgpr_write_b32 a3, v5
  v_accvgpr_read_b32 v2, a4
  v_accvgpr_read_b32 v3, a5
  v_accvgpr_read_b32 v4, a6
  v_accvgpr_read_b32 v5, a7
  v_mul_f32 v2, v2, v1
  v_mul_f32 v3, v3, v1
  v_mul_f32 v4, v4, v1
  v_mul_f32 v5, v5, v1
  v_accvgpr_write_b32 a4, v2
  v_accvgpr_write_b32 a5, v3
  v_accvgpr_write_b32 a6, v4
  v_accvgpr_write_b32 a7, v5
  v_accvgpr_read_b32 v2, a8
  v_accvgpr_read_b32 v3, a9
  v_accvgpr_read_b32 v4, a10
  v_accvgpr_read_b32 v5, a11
  v_mul_f32 v2, v2, v1
  v_mul_f32 v3, v3, v1
  v_mul_f32 v4, v4, v1
  v_mul_f32 v5, v5, v1
  v_accvgpr_write_b32 a8, v2
  v_accvgpr_write_b32 a9, v3
  v_accvgpr_write_b32 a10, v4
  v_accvgpr_write_b32 a11, v5
  v_accvgpr_read_b32 v2, a12
  v_accvgpr_read_b32 v3, a13
  v_accvgpr_read_b32 v4, a14
  v_accvgpr_read_b32 v5, a15
  v_mul_f32 v2, v2, v1
  v_mul_f32 v3, v3, v1
  v_mul_f32 v4, v4, v1
  v_mul_f32 v5, v5, v1
  v_accvgpr_write_b32 a12, v2
  v_accvgpr_write_b32 a13, v3
  v_accvgpr_write_b32 a14, v4
  v_accvgpr_write_b32 a15, v5
  v_accvgpr_read_b32 v2, a16
  v_accvgpr_read_b32 v3, a17
  v_accvgpr_read_b32 v4, a18
  v_accvgpr_read_b32 v5, a19
  v_mul_f32 v2, v2, v1
  v_mul_f32 v3, v3, v1
  v_mul_f32 v4, v4, v1
  v_mul_f32 v5, v5, v1
  v_accvgpr_write_b32 a16, v2
  v_accvgpr_write_b32 a17, v3
  v_accvgpr_write_b32 a18, v4
  v_accvgpr_write_b32 a19, v5
  v_accvgpr_read_b32 v2, a20
  v_accvgpr_read_b32 v3, a21
  v_accvgpr_read_b32 v4, a22
  v_accvgpr_read_b32 v5, a23
  v_mul_f32 v2, v2, v1
  v_mul_f32 v3, v3, v1
  v_mul_f32 v4, v4, v1
  v_mul_f32 v5, v5, v1
  v_accvgpr_write_b32 a20, v2
  v_accvgpr_write_b32 a21, v3
  v_accvgpr_write_b32 a22, v4
  v_accvgpr_write_b32 a23, v5
  v_accvgpr_read_b32 v2, a24
  v_accvgpr_read_b32 v3, a25
  v_accvgpr_read_b32 v4, a26
  v_accvgpr_read_b32 v5, a27
  v_mul_f32 v2, v2, v1
  v_mul_f32 v3, v3, v1
  v_mul_f32 v4, v4, v1
  v_mul_f32 v5, v5, v1
  v_accvgpr_write_b32 a24, v2
  v_accvgpr_write_b32 a25, v3
  v_accvgpr_write_b32 a26, v4
  v_accvgpr_write_b32 a27, v5
  v_accvgpr_read_b32 v2, a28
  v_accvgpr_read_b32 v3, a29
  v_accvgpr_read_b32 v4, a30
  v_accvgpr_read_b32 v5, a31
  v_mul_f32 v2, v2, v1
  v_mul_f32 v3, v3, v1
  v_mul_f32 v4, v4, v1
  v_mul_f32 v5, v5, v1
  v_accvgpr_write_b32 a28, v2
  v_accvgpr_write_b32 a29, v3
  v_accvgpr_write_b32 a30, v4
  v_accvgpr_write_b32 a31, v5
  v_exp_f32 v2, v64
  v_exp_f32 v3, v65
  v_exp_f32 v4, v66
  v_exp_f32 v5, v67
  v_exp_f32 v6, v68
  v_exp_f32 v7, v69
  v_exp_f32 v8, v70
  v_exp_f32 v9, v71
  s_nop 0
  v_add_f32 v200, v2, v3
  v_add_f32 v200, v200, v4
  v_add_f32 v200, v200, v5
  v_add_f32 v200, v200, v6
  v_add_f32 v200, v200, v7
  v_add_f32 v200, v200, v8
  v_add_f32 v200, v200, v9
  v_cvt_pk_bf16_f32 v112, v2, v3
  v_cvt_pk_bf16_f32 v113, v4, v5
  v_cvt_pk_bf16_f32 v114, v6, v7
  v_cvt_pk_bf16_f32 v115, v8, v9
  v_max3_f32 v0, v72, v73, v74
  v_max3_f32 v0, v0, v75, v76
  v_max3_f32 v0, v0, v77, v78
  v_max3_f32 v0, v0, v79, 0
  v_mov_b32 v1, v0
  s_nop 1
  v_permlane32_swap_b32 v0, v1
  s_nop 1
  v_max_f32 v0, v0, v1
  v_mov_b32 v1, v0
  s_nop 1
  v_permlane16_swap_b32 v0, v1
  s_nop 1
  v_max_f32 v0, v0, v1
  v_exp_f32 v1, -v0
  v_sub_f32 v100, v100, v0
  v_sub_f32 v101, v101, v0
  v_sub_f32 v102, v102, v0
  v_sub_f32 v103, v103, v0
  v_sub_f32 v72, v72, v0
  v_sub_f32 v73, v73, v0
  v_sub_f32 v74, v74, v0
  v_sub_f32 v75, v75, v0
  v_sub_f32 v76, v76, v0
  v_sub_f32 v77, v77, v0
  v_sub_f32 v78, v78, v0
  v_sub_f32 v79, v79, v0
  v_sub_f32 v40, v40, v0
  v_sub_f32 v41, v41, v0
  v_sub_f32 v42, v42, v0
  v_sub_f32 v43, v43, v0
  v_sub_f32 v44, v44, v0
  v_sub_f32 v45, v45, v0
  v_sub_f32 v46, v46, v0
  v_sub_f32 v47, v47, v0
  v_mul_f32 v205, v205, v1
  v_accvgpr_read_b32 v2, a32
  v_accvgpr_read_b32 v3, a33
  v_accvgpr_read_b32 v4, a34
  v_accvgpr_read_b32 v5, a35
  v_mul_f32 v2, v2, v1
  v_mul_f32 v3, v3, v1
  v_mul_f32 v4, v4, v1
  v_mul_f32 v5, v5, v1
  v_accvgpr_write_b32 a32, v2
  v_accvgpr_write_b32 a33, v3
  v_accvgpr_write_b32 a34, v4
  v_accvgpr_write_b32 a35, v5
  v_accvgpr_read_b32 v2, a36
  v_accvgpr_read_b32 v3, a37
  v_accvgpr_read_b32 v4, a38
  v_accvgpr_read_b32 v5, a39
  v_mul_f32 v2, v2, v1
  v_mul_f32 v3, v3, v1
  v_mul_f32 v4, v4, v1
  v_mul_f32 v5, v5, v1
  v_accvgpr_write_b32 a36, v2
  v_accvgpr_write_b32 a37, v3
  v_accvgpr_write_b32 a38, v4
  v_accvgpr_write_b32 a39, v5
  v_accvgpr_read_b32 v2, a40
  v_accvgpr_read_b32 v3, a41
  v_accvgpr_read_b32 v4, a42
  v_accvgpr_read_b32 v5, a43
  v_mul_f32 v2, v2, v1
  v_mul_f32 v3, v3, v1
  v_mul_f32 v4, v4, v1
  v_mul_f32 v5, v5, v1
  v_accvgpr_write_b32 a40, v2
  v_accvgpr_write_b32 a41, v3
  v_accvgpr_write_b32 a42, v4
  v_accvgpr_write_b32 a43, v5
  v_accvgpr_read_b32 v2, a44
  v_accvgpr_read_b32 v3, a45
  v_accvgpr_read_b32 v4, a46
  v_accvgpr_read_b32 v5, a47
  v_mul_f32 v2, v2, v1
  v_mul_f32 v3, v3, v1
  v_mul_f32 v4, v4, v1
  v_mul_f32 v5, v5, v1
  v_accvgpr_write_b32 a44, v2
  v_accvgpr_write_b32 a45, v3
  v_accvgpr_write_b32 a46, v4
  v_accvgpr_write_b32 a47, v5
  v_accvgpr_read_b32 v2, a48
  v_accvgpr_read_b32 v3, a49
  v_accvgpr_read_b32 v4, a50
  v_accvgpr_read_b32 v5, a51
  v_mul_f32 v2, v2, v1
  v_mul_f32 v3, v3, v1
  v_mul_f32 v4, v4, v1
  v_mul_f32 v5, v5, v1
  v_accvgpr_write_b32 a48, v2
  v_accvgpr_write_b32 a49, v3
  v_accvgpr_write_b32 a50, v4
  v_accvgpr_write_b32 a51, v5
  v_accvgpr_read_b32 v2, a52
  v_accvgpr_read_b32 v3, a53
  v_accvgpr_read_b32 v4, a54
  v_accvgpr_read_b32 v5, a55
  v_mul_f32 v2, v2, v1
  v_mul_f32 v3, v3, v1
  v_mul_f32 v4, v4, v1
  v_mul_f32 v5, v5, v1
  v_accvgpr_write_b32 a52, v2
  v_accvgpr_write_b32 a53, v3
  v_accvgpr_write_b32 a54, v4
  v_accvgpr_write_b32 a55, v5
  v_accvgpr_read_b32 v2, a56
  v_accvgpr_read_b32 v3, a57
  v_accvgpr_read_b32 v4, a58
  v_accvgpr_read_b32 v5, a59
  v_mul_f32 v2, v2, v1
  v_mul_f32 v3, v3, v1
  v_mul_f32 v4, v4, v1
  v_mul_f32 v5, v5, v1
  v_accvgpr_write_b32 a56, v2
  v_accvgpr_write_b32 a57, v3
  v_accvgpr_write_b32 a58, v4
  v_accvgpr_write_b32 a59, v5
  v_accvgpr_read_b32 v2, a60
  v_accvgpr_read_b32 v3, a61
  v_accvgpr_read_b32 v4, a62
  v_accvgpr_read_b32 v5, a63
  v_mul_f32 v2, v2, v1
  v_mul_f32 v3, v3, v1
  v_mul_f32 v4, v4, v1
  v_mul_f32 v5, v5, v1
  v_accvgpr_write_b32 a60, v2
  v_accvgpr_write_b32 a61, v3
  v_accvgpr_write_b32 a62, v4
  v_accvgpr_write_b32 a63, v5
  v_exp_f32 v2, v72
  v_exp_f32 v3, v73
  v_exp_f32 v4, v74
  v_exp_f32 v5, v75
  v_exp_f32 v6, v76
  v_exp_f32 v7, v77
  v_exp_f32 v8, v78
  v_exp_f32 v9, v79
  s_nop 0
  v_add_f32 v201, v2, v3
  v_add_f32 v201, v201, v4
  v_add_f32 v201, v201, v5
  v_add_f32 v201, v201, v6
  v_add_f32 v201, v201, v7
  v_add_f32 v201, v201, v8
  v_add_f32 v201, v201, v9
  v_cvt_pk_bf16_f32 v116, v2, v3
  v_cvt_pk_bf16_f32 v117, v4, v5
  v_cvt_pk_bf16_f32 v118, v6, v7
  v_cvt_pk_bf16_f32 v119, v8, v9
  s_nop 3
  s_branch KA_R01B
KA_R10:
  s_nop 15
  v_max3_f32 v0, v80, v81, v82
  v_max3_f32 v0, v0, v83, v84
  v_max3_f32 v0, v0, v85, v86
  v_max3_f32 v0, v0, v87, 0
  v_mov_b32 v1, v0
  s_nop 1
  v_permlane32_swap_b32 v0, v1
  s_nop 1
  v_max_f32 v0, v0, v1
  v_mov_b32 v1, v0
  s_nop 1
  v_permlane16_swap_b32 v0, v1
  s_nop 1
  v_max_f32 v0, v0, v1
  v_exp_f32 v1, -v0
  v_sub_f32 v104, v104, v0
  v_sub_f32 v105, v105, v0
  v_sub_f32 v106, v106, v0
  v_sub_f32 v107, v107, v0
  v_sub_f32 v80, v80, v0
  v_sub_f32 v81, v81, v0
  v_sub_f32 v82, v82, v0
  v_sub_f32 v83, v83, v0
  v_sub_f32 v84, v84, v0
  v_sub_f32 v85, v85, v0
  v_sub_f32 v86, v86, v0
  v_sub_f32 v87, v87, v0
  v_sub_f32 v48, v48, v0
  v_sub_f32 v49, v49, v0
  v_sub_f32 v50, v50, v0
  v_sub_f32 v51, v51, v0
  v_sub_f32 v52, v52, v0
  v_sub_f32 v53, v53, v0
  v_sub_f32 v54, v54, v0
  v_sub_f32 v55, v55, v0
  v_mul_f32 v206, v206, v1
  v_accvgpr_read_b32 v2, a64
  v_accvgpr_read_b32 v3, a65
  v_accvgpr_read_b32 v4, a66
  v_accvgpr_read_b32 v5, a67
  v_mul_f32 v2, v2, v1
  v_mul_f32 v3, v3, v1
  v_mul_f32 v4, v4, v1
  v_mul_f32 v5, v5, v1
  v_accvgpr_write_b32 a64, v2
  v_accvgpr_write_b32 a65, v3
  v_accvgpr_write_b32 a66, v4
  v_accvgpr_write_b32 a67, v5
  v_accvgpr_read_b32 v2, a68
  v_accvgpr_read_b32 v3, a69
  v_accvgpr_read_b32 v4, a70
  v_accvgpr_read_b32 v5, a71
  v_mul_f32 v2, v2, v1
  v_mul_f32 v3, v3, v1
  v_mul_f32 v4, v4, v1
  v_mul_f32 v5, v5, v1
  v_accvgpr_write_b32 a68, v2
  v_accvgpr_write_b32 a69, v3
  v_accvgpr_write_b32 a70, v4
  v_accvgpr_write_b32 a71, v5
  v_accvgpr_read_b32 v2, a72
  v_accvgpr_read_b32 v3, a73
  v_accvgpr_read_b32 v4, a74
  v_accvgpr_read_b32 v5, a75
  v_mul_f32 v2, v2, v1
  v_mul_f32 v3, v3, v1
  v_mul_f32 v4, v4, v1
  v_mul_f32 v5, v5, v1
  v_accvgpr_write_b32 a72, v2
  v_accvgpr_write_b32 a73, v3
  v_accvgpr_write_b32 a74, v4
  v_accvgpr_write_b32 a75, v5
  v_accvgpr_read_b32 v2, a76
  v_accvgpr_read_b32 v3, a77
  v_accvgpr_read_b32 v4, a78
  v_accvgpr_read_b32 v5, a79
  v_mul_f32 v2, v2, v1
  v_mul_f32 v3, v3, v1
  v_mul_f32 v4, v4, v1
  v_mul_f32 v5, v5, v1
  v_accvgpr_write_b32 a76, v2
  v_accvgpr_write_b32 a77, v3
  v_accvgpr_write_b32 a78, v4
  v_accvgpr_write_b32 a79, v5
  v_accvgpr_read_b32 v2, a80
  v_accvgpr_read_b32 v3, a81
  v_accvgpr_read_b32 v4, a82
  v_accvgpr_read_b32 v5, a83
  v_mul_f32 v2, v2, v1
  v_mul_f32 v3, v3, v1
  v_mul_f32 v4, v4, v1
  v_mul_f32 v5, v5, v1
  v_accvgpr_write_b32 a80, v2
  v_accvgpr_write_b32 a81, v3
  v_accvgpr_write_b32 a82, v4
  v_accvgpr_write_b32 a83, v5
  v_accvgpr_read_b32 v2, a84
  v_accvgpr_read_b32 v3, a85
  v_accvgpr_read_b32 v4, a86
  v_accvgpr_read_b32 v5, a87
  v_mul_f32 v2, v2, v1
  v_mul_f32 v3, v3, v1
  v_mul_f32 v4, v4, v1
  v_mul_f32 v5, v5, v1
  v_accvgpr_write_b32 a84, v2
  v_accvgpr_write_b32 a85, v3
  v_accvgpr_write_b32 a86, v4
  v_accvgpr_write_b32 a87, v5
  v_accvgpr_read_b32 v2, a88
  v_accvgpr_read_b32 v3, a89
  v_accvgpr_read_b32 v4, a90
  v_accvgpr_read_b32 v5, a91
  v_mul_f32 v2, v2, v1
  v_mul_f32 v3, v3, v1
  v_mul_f32 v4, v4, v1
  v_mul_f32 v5, v5, v1
  v_accvgpr_write_b32 a88, v2
  v_accvgpr_write_b32 a89, v3
  v_accvgpr_write_b32 a90, v4
  v_accvgpr_write_b32 a91, v5
  v_accvgpr_read_b32 v2, a92
  v_accvgpr_read_b32 v3, a93
  v_accvgpr_read_b32 v4, a94
  v_accvgpr_read_b32 v5, a95
  v_mul_f32 v2, v2, v1
  v_mul_f32 v3, v3, v1
  v_mul_f32 v4, v4, v1
  v_mul_f32 v5, v5, v1
  v_accvgpr_write_b32 a92, v2
  v_accvgpr_write_b32 a93, v3
  v_accvgpr_write_b32 a94, v4
  v_accvgpr_write_b32 a95, v5
  v_exp_f32 v2, v80
  v_exp_f32 v3, v81
  v_exp_f32 v4, v82
  v_exp_f32 v5, v83
  v_exp_f32 v6, v84
  v_exp_f32 v7, v85
  v_exp_f32 v8, v86
  v_exp_f32 v9, v87
  s_nop 0
  v_add_f32 v202, v2, v3
  v_add_f32 v202, v202, v4
  v_add_f32 v202, v202, v5
  v_add_f32 v202, v202, v6
  v_add_f32 v202, v202, v7
  v_add_f32 v202, v202, v8
  v_add_f32 v202, v202, v9
  v_cvt_pk_bf16_f32 v120, v2, v3
  v_cvt_pk_bf16_f32 v121, v4, v5
  v_cvt_pk_bf16_f32 v122, v6, v7
  v_cvt_pk_bf16_f32 v123, v8, v9
  v_max3_f32 v0, v88, v89, v90
  v_max3_f32 v0, v0, v91, v92
  v_max3_f32 v0, v0, v93, v94
  v_max3_f32 v0, v0, v95, 0
  v_mov_b32 v1, v0
  s_nop 1
  v_permlane32_swap_b32 v0, v1
  s_nop 1
  v_max_f32 v0, v0, v1
  v_mov_b32 v1, v0
  s_nop 1
  v_permlane16_swap_b32 v0, v1
  s_nop 1
  v_max_f32 v0, v0, v1
  v_exp_f32 v1, -v0
  v_sub_f32 v108, v108, v0
  v_sub_f32 v109, v109, v0
  v_sub_f32 v110, v110, v0
  v_sub_f32 v111, v111, v0
  v_sub_f32 v88, v88, v0
  v_sub_f32 v89, v89, v0
  v_sub_f32 v90, v90, v0
  v_sub_f32 v91, v91, v0
  v_sub_f32 v92, v92, v0
  v_sub_f32 v93, v93, v0
  v_sub_f32 v94, v94, v0
  v_sub_f32 v95, v95, v0
  v_sub_f32 v56, v56, v0
  v_sub_f32 v57, v57, v0
  v_sub_f32 v58, v58, v0
  v_sub_f32 v59, v59, v0
  v_sub_f32 v60, v60, v0
  v_sub_f32 v61, v61, v0
  v_sub_f32 v62, v62, v0
  v_sub_f32 v63, v63, v0
  v_mul_f32 v207, v207, v1
  v_accvgpr_read_b32 v2, a96
  v_accvgpr_read_b32 v3, a97
  v_accvgpr_read_b32 v4, a98
  v_accvgpr_read_b32 v5, a99
  v_mul_f32 v2, v2, v1
  v_mul_f32 v3, v3, v1
  v_mul_f32 v4, v4, v1
  v_mul_f32 v5, v5, v1
  v_accvgpr_write_b32 a96, v2
  v_accvgpr_write_b32 a97, v3
  v_accvgpr_write_b32 a98, v4
  v_accvgpr_write_b32 a99, v5
  v_accvgpr_read_b32 v2, a100
  v_accvgpr_read_b32 v3, a101
  v_accvgpr_read_b32 v4, a102
  v_accvgpr_read_b32 v5, a103
  v_mul_f32 v2, v2, v1
  v_mul_f32 v3, v3, v1
  v_mul_f32 v4, v4, v1
  v_mul_f32 v5, v5, v1
  v_accvgpr_write_b32 a100, v2
  v_accvgpr_write_b32 a101, v3
  v_accvgpr_write_b32 a102, v4
  v_accvgpr_write_b32 a103, v5
  v_accvgpr_read_b32 v2, a104
  v_accvgpr_read_b32 v3, a105
  v_accvgpr_read_b32 v4, a106
  v_accvgpr_read_b32 v5, a107
  v_mul_f32 v2, v2, v1
  v_mul_f32 v3, v3, v1
  v_mul_f32 v4, v4, v1
  v_mul_f32 v5, v5, v1
  v_accvgpr_write_b32 a104, v2
  v_accvgpr_write_b32 a105, v3
  v_accvgpr_write_b32 a106, v4
  v_accvgpr_write_b32 a107, v5
  v_accvgpr_read_b32 v2, a108
  v_accvgpr_read_b32 v3, a109
  v_accvgpr_read_b32 v4, a110
  v_accvgpr_read_b32 v5, a111
  v_mul_f32 v2, v2, v1
  v_mul_f32 v3, v3, v1
  v_mul_f32 v4, v4, v1
  v_mul_f32 v5, v5, v1
  v_accvgpr_write_b32 a108, v2
  v_accvgpr_write_b32 a109, v3
  v_accvgpr_write_b32 a110, v4
  v_accvgpr_write_b32 a111, v5
  v_accvgpr_read_b32 v2, a112
  v_accvgpr_read_b32 v3, a113
  v_accvgpr_read_b32 v4, a114
  v_accvgpr_read_b32 v5, a115
  v_mul_f32 v2, v2, v1
  v_mul_f32 v3, v3, v1
  v_mul_f32 v4, v4, v1
  v_mul_f32 v5, v5, v1
  v_accvgpr_write_b32 a112, v2
  v_accvgpr_write_b32 a113, v3
  v_accvgpr_write_b32 a114, v4
  v_accvgpr_write_b32 a115, v5
  v_accvgpr_read_b32 v2, a116
  v_accvgpr_read_b32 v3, a117
  v_accvgpr_read_b32 v4, a118
  v_accvgpr_read_b32 v5, a119
  v_mul_f32 v2, v2, v1
  v_mul_f32 v3, v3, v1
  v_mul_f32 v4, v4, v1
  v_mul_f32 v5, v5, v1
  v_accvgpr_write_b32 a116, v2
  v_accvgpr_write_b32 a117, v3
  v_accvgpr_write_b32 a118, v4
  v_accvgpr_write_b32 a119, v5
  v_accvgpr_read_b32 v2, a120
  v_accvgpr_read_b32 v3, a121
  v_accvgpr_read_b32 v4, a122
  v_accvgpr_read_b32 v5, a123
  v_mul_f32 v2, v2, v1
  v_mul_f32 v3, v3, v1
  v_mul_f32 v4, v4, v1
  v_mul_f32 v5, v5, v1
  v_accvgpr_write_b32 a120, v2
  v_accvgpr_write_b32 a121, v3
  v_accvgpr_write_b32 a122, v4
  v_accvgpr_write_b32 a123, v5
  v_accvgpr_read_b32 v2, a124
  v_accvgpr_read_b32 v3, a125
  v_accvgpr_read_b32 v4, a126
  v_accvgpr_read_b32 v5, a127
  v_mul_f32 v2, v2, v1
  v_mul_f32 v3, v3, v1
  v_mul_f32 v4, v4, v1
  v_mul_f32 v5, v5, v1
  v_accvgpr_write_b32 a124, v2
  v_accvgpr_write_b32 a125, v3
  v_accvgpr_write_b32 a126, v4
  v_accvgpr_write_b32 a127, v5
  v_exp_f32 v2, v88
  v_exp_f32 v3, v89
  v_exp_f32 v4, v90
  v_exp_f32 v5, v91
  v_exp_f32 v6, v92
  v_exp_f32 v7, v93
  v_exp_f32 v8, v94
  v_exp_f32 v9, v95
  s_nop 0
  v_add_f32 v203, v2, v3
  v_add_f32 v203, v203, v4
  v_add_f32 v203, v203, v5
  v_add_f32 v203, v203, v6
  v_add_f32 v203, v203, v7
  v_add_f32 v203, v203, v8
  v_add_f32 v203, v203, v9
  v_cvt_pk_bf16_f32 v124, v2, v3
  v_cvt_pk_bf16_f32 v125, v4, v5
  v_cvt_pk_bf16_f32 v126, v6, v7
  v_cvt_pk_bf16_f32 v127, v8, v9
  s_nop 3
  s_branch KA_R10B
KA_R11:
  s_nop 15
  v_max3_f32 v0, v32, v33, v34
  v_max3_f32 v0, v0, v35, v36
  v_max3_f32 v0, v0, v37, v38
  v_max3_f32 v0, v0, v39, 0
  v_mov_b32 v1, v0
  s_nop 1
  v_permlane32_swap_b32 v0, v1
  s_nop 1
  v_max_f32 v0, v0, v1
  v_mov_b32 v1, v0
  s_nop 1
  v_permlane16_swap_b32 v0, v1
  s_nop 1
  v_max_f32 v0, v0, v1
  v_exp_f32 v1, -v0
  v_sub_f32 v96, v96, v0
  v_sub_f32 v97, v97, v0
  v_sub_f32 v98, v98, v0
  v_sub_f32 v99, v99, v0
  v_sub_f32 v32, v32, v0
  v_sub_f32 v33, v33, v0
  v_sub_f32 v34, v34, v0
  v_sub_f32 v35, v35, v0
  v_sub_f32 v36, v36, v0
  v_sub_f32 v37, v37, v0
  v_sub_f32 v38, v38, v0
  v_sub_f32 v39, v39, v0
  v_sub_f32 v64, v64, v0
  v_sub_f32 v65, v65, v0
  v_sub_f32 v66, v66, v0
  v_sub_f32 v67, v67, v0
  v_sub_f32 v68, v68, v0
  v_sub_f32 v69, v69, v0
  v_sub_f32 v70, v70, v0
  v_sub_f32 v71, v71, v0
  v_mul_f32 v204, v204, v1
  v_accvgpr_read_b32 v2, a0
  v_accvgpr_read_b32 v3, a1
  v_accvgpr_read_b32 v4, a2
  v_accvgpr_read_b32 v5, a3
  v_mul_f32 v2, v2, v1
  v_mul_f32 v3, v3, v1
  v_mul_f32 v4, v4, v1
  v_mul_f32 v5, v5, v1
  v_accvgpr_write_b32 a0, v2
  v_accvgpr_write_b32 a1, v3
  v_accvgpr_write_b32 a2, v4
  v_accvgpr_write_b32 a3, v5
  v_accvgpr_read_b32 v2, a4
  v_accvgpr_read_b32 v3, a5
  v_accvgpr_read_b32 v4, a6
  v_accvgpr_read_b32 v5, a7
  v_mul_f32 v2, v2, v1
  v_mul_f32 v3, v3, v1
  v_mul_f32 v4, v4, v1
  v_mul_f32 v5, v5, v1
  v_accvgpr_write_b32 a4, v2
  v_accvgpr_write_b32 a5, v3
  v_accvgpr_write_b32 a6, v4
  v_accvgpr_write_b32 a7, v5
  v_accvgpr_read_b32 v2, a8
  v_accvgpr_read_b32 v3, a9
  v_accvgpr_read_b32 v4, a10
  v_accvgpr_read_b32 v5, a11
  v_mul_f32 v2, v2, v1
  v_mul_f32 v3, v3, v1
  v_mul_f32 v4, v4, v1
  v_mul_f32 v5, v5, v1
  v_accvgpr_write_b32 a8, v2
  v_accvgpr_write_b32 a9, v3
  v_accvgpr_write_b32 a10, v4
  v_accvgpr_write_b32 a11, v5
  v_accvgpr_read_b32 v2, a12
  v_accvgpr_read_b32 v3, a13
  v_accvgpr_read_b32 v4, a14
  v_accvgpr_read_b32 v5, a15
  v_mul_f32 v2, v2, v1
  v_mul_f32 v3, v3, v1
  v_mul_f32 v4, v4, v1
  v_mul_f32 v5, v5, v1
  v_accvgpr_write_b32 a12, v2
  v_accvgpr_write_b32 a13, v3
  v_accvgpr_write_b32 a14, v4
  v_accvgpr_write_b32 a15, v5
  v_accvgpr_read_b32 v2, a16
  v_accvgpr_read_b32 v3, a17
  v_accvgpr_read_b32 v4, a18
  v_accvgpr_read_b32 v5, a19
  v_mul_f32 v2, v2, v1
  v_mul_f32 v3, v3, v1
  v_mul_f32 v4, v4, v1
  v_mul_f32 v5, v5, v1
  v_accvgpr_write_b32 a16, v2
  v_accvgpr_write_b32 a17, v3
  v_accvgpr_write_b32 a18, v4
  v_accvgpr_write_b32 a19, v5
  v_accvgpr_read_b32 v2, a20
  v_accvgpr_read_b32 v3, a21
  v_accvgpr_read_b32 v4, a22
  v_accvgpr_read_b32 v5, a23
  v_mul_f32 v2, v2, v1
  v_mul_f32 v3, v3, v1
  v_mul_f32 v4, v4, v1
  v_mul_f32 v5, v5, v1
  v_accvgpr_write_b32 a20, v2
  v_accvgpr_write_b32 a21, v3
  v_accvgpr_write_b32 a22, v4
  v_accvgpr_write_b32 a23, v5
  v_accvgpr_read_b32 v2, a24
  v_accvgpr_read_b32 v3, a25
  v_accvgpr_read_b32 v4, a26
  v_accvgpr_read_b32 v5, a27
  v_mul_f32 v2, v2, v1
  v_mul_f32 v3, v3, v1
  v_mul_f32 v4, v4, v1
  v_mul_f32 v5, v5, v1
  v_accvgpr_write_b32 a24, v2
  v_accvgpr_write_b32 a25, v3
  v_accvgpr_write_b32 a26, v4
  v_accvgpr_write_b32 a27, v5
  v_accvgpr_read_b32 v2, a28
  v_accvgpr_read_b32 v3, a29
  v_accvgpr_read_b32 v4, a30
  v_accvgpr_read_b32 v5, a31
  v_mul_f32 v2, v2, v1
  v_mul_f32 v3, v3, v1
  v_mul_f32 v4, v4, v1
  v_mul_f32 v5, v5, v1
  v_accvgpr_write_b32 a28, v2
  v_accvgpr_write_b32 a29, v3
  v_accvgpr_write_b32 a30, v4
  v_accvgpr_write_b32 a31, v5
  v_exp_f32 v2, v32
  v_exp_f32 v3, v33
  v_exp_f32 v4, v34
  v_exp_f32 v5, v35
  v_exp_f32 v6, v36
  v_exp_f32 v7, v37
  v_exp_f32 v8, v38
  v_exp_f32 v9, v39
  s_nop 0
  v_add_f32 v200, v2, v3
  v_add_f32 v200, v200, v4
  v_add_f32 v200, v200, v5
  v_add_f32 v200, v200, v6
  v_add_f32 v200, v200, v7
  v_add_f32 v200, v200, v8
  v_add_f32 v200, v200, v9
  v_cvt_pk_bf16_f32 v112, v2, v3
  v_cvt_pk_bf16_f32 v113, v4, v5
  v_cvt_pk_bf16_f32 v114, v6, v7
  v_cvt_pk_bf16_f32 v115, v8, v9
  v_max3_f32 v0, v40, v41, v42
  v_max3_f32 v0, v0, v43, v44
  v_max3_f32 v0, v0, v45, v46
  v_max3_f32 v0, v0, v47, 0
  v_mov_b32 v1, v0
  s_nop 1
  v_permlane32_swap_b32 v0, v1
  s_nop 1
  v_max_f32 v0, v0, v1
  v_mov_b32 v1, v0
  s_nop 1
  v_permlane16_swap_b32 v0, v1
  s_nop 1
  v_max_f32 v0, v0, v1
  v_exp_f32 v1, -v0
  v_sub_f32 v100, v100, v0
  v_sub_f32 v101, v101, v0
  v_sub_f32 v102, v102, v0
  v_sub_f32 v103, v103, v0
  v_sub_f32 v40, v40, v0
  v_sub_f32 v41, v41, v0
  v_sub_f32 v42, v42, v0
  v_sub_f32 v43, v43, v0
  v_sub_f32 v44, v44, v0
  v_sub_f32 v45, v45, v0
  v_sub_f32 v46, v46, v0
  v_sub_f32 v47, v47, v0
  v_sub_f32 v72, v72, v0
  v_sub_f32 v73, v73, v0
  v_sub_f32 v74, v74, v0
  v_sub_f32 v75, v75, v0
  v_sub_f32 v76, v76, v0
  v_sub_f32 v77, v77, v0
  v_sub_f32 v78, v78, v0
  v_sub_f32 v79, v79, v0
  v_mul_f32 v205, v205, v1
  v_accvgpr_read_b32 v2, a32
  v_accvgpr_read_b32 v3, a33
  v_accvgpr_read_b32 v4, a34
  v_accvgpr_read_b32 v5, a35
  v_mul_f32 v2, v2, v1
  v_mul_f32 v3, v3, v1
  v_mul_f32 v4, v4, v1
  v_mul_f32 v5, v5, v1
  v_accvgpr_write_b32 a32, v2
  v_accvgpr_write_b32 a33, v3
  v_accvgpr_write_b32 a34, v4
  v_accvgpr_write_b32 a35, v5
  v_accvgpr_read_b32 v2, a36
  v_accvgpr_read_b32 v3, a37
  v_accvgpr_read_b32 v4, a38
  v_accvgpr_read_b32 v5, a39
  v_mul_f32 v2, v2, v1
  v_mul_f32 v3, v3, v1
  v_mul_f32 v4, v4, v1
  v_mul_f32 v5, v5, v1
  v_accvgpr_write_b32 a36, v2
  v_accvgpr_write_b32 a37, v3
  v_accvgpr_write_b32 a38, v4
  v_accvgpr_write_b32 a39, v5
  v_accvgpr_read_b32 v2, a40
  v_accvgpr_read_b32 v3, a41
  v_accvgpr_read_b32 v4, a42
  v_accvgpr_read_b32 v5, a43
  v_mul_f32 v2, v2, v1
  v_mul_f32 v3, v3, v1
  v_mul_f32 v4, v4, v1
  v_mul_f32 v5, v5, v1
  v_accvgpr_write_b32 a40, v2
  v_accvgpr_write_b32 a41, v3
  v_accvgpr_write_b32 a42, v4
  v_accvgpr_write_b32 a43, v5
  v_accvgpr_read_b32 v2, a44
  v_accvgpr_read_b32 v3, a45
  v_accvgpr_read_b32 v4, a46
  v_accvgpr_read_b32 v5, a47
  v_mul_f32 v2, v2, v1
  v_mul_f32 v3, v3, v1
  v_mul_f32 v4, v4, v1
  v_mul_f32 v5, v5, v1
  v_accvgpr_write_b32 a44, v2
  v_accvgpr_write_b32 a45, v3
  v_accvgpr_write_b32 a46, v4
  v_accvgpr_write_b32 a47, v5
  v_accvgpr_read_b32 v2, a48
  v_accvgpr_read_b32 v3, a49
  v_accvgpr_read_b32 v4, a50
  v_accvgpr_read_b32 v5, a51
  v_mul_f32 v2, v2, v1
  v_mul_f32 v3, v3, v1
  v_mul_f32 v4, v4, v1
  v_mul_f32 v5, v5, v1
  v_accvgpr_write_b32 a48, v2
  v_accvgpr_write_b32 a49, v3
  v_accvgpr_write_b32 a50, v4
  v_accvgpr_write_b32 a51, v5
  v_accvgpr_read_b32 v2, a52
  v_accvgpr_read_b32 v3, a53
  v_accvgpr_read_b32 v4, a54
  v_accvgpr_read_b32 v5, a55
  v_mul_f32 v2, v2, v1
  v_mul_f32 v3, v3, v1
  v_mul_f32 v4, v4, v1
  v_mul_f32 v5, v5, v1
  v_accvgpr_write_b32 a52, v2
  v_accvgpr_write_b32 a53, v3
  v_accvgpr_write_b32 a54, v4
  v_accvgpr_write_b32 a55, v5
  v_accvgpr_read_b32 v2, a56
  v_accvgpr_read_b32 v3, a57
  v_accvgpr_read_b32 v4, a58
  v_accvgpr_read_b32 v5, a59
  v_mul_f32 v2, v2, v1
  v_mul_f32 v3, v3, v1
  v_mul_f32 v4, v4, v1
  v_mul_f32 v5, v5, v1
  v_accvgpr_write_b32 a56, v2
  v_accvgpr_write_b32 a57, v3
  v_accvgpr_write_b32 a58, v4
  v_accvgpr_write_b32 a59, v5
  v_accvgpr_read_b32 v2, a60
  v_accvgpr_read_b32 v3, a61
  v_accvgpr_read_b32 v4, a62
  v_accvgpr_read_b32 v5, a63
  v_mul_f32 v2, v2, v1
  v_mul_f32 v3, v3, v1
  v_mul_f32 v4, v4, v1
  v_mul_f32 v5, v5, v1
  v_accvgpr_write_b32 a60, v2
  v_accvgpr_write_b32 a61, v3
  v_accvgpr_write_b32 a62, v4
  v_accvgpr_write_b32 a63, v5
  v_exp_f32 v2, v40
  v_exp_f32 v3, v41
  v_exp_f32 v4, v42
  v_exp_f32 v5, v43
  v_exp_f32 v6, v44
  v_exp_f32 v7, v45
  v_exp_f32 v8, v46
  v_exp_f32 v9, v47
  s_nop 0
  v_add_f32 v201, v2, v3
  v_add_f32 v201, v201, v4
  v_add_f32 v201, v201, v5
  v_add_f32 v201, v201, v6
  v_add_f32 v201, v201, v7
  v_add_f32 v201, v201, v8
  v_add_f32 v201, v201, v9
  v_cvt_pk_bf16_f32 v116, v2, v3
  v_cvt_pk_bf16_f32 v117, v4, v5
  v_cvt_pk_bf16_f32 v118, v6, v7
  v_cvt_pk_bf16_f32 v119, v8, v9
  s_nop 3
  s_branch KA_R11B
TEXT_END:
.section .rodata,"a"
.p2align 6
.amdhsa_kernel ka_kernel
  .amdhsa_next_free_vgpr 512
  .amdhsa_next_free_sgpr 92
  .amdhsa_accum_offset 256
  .amdhsa_group_segment_fixed_size 0
  .amdhsa_kernarg_size 96
  .amdhsa_user_sgpr_count 2
  .amdhsa_user_sgpr_kernarg_segment_ptr 1
  .amdhsa_system_sgpr_workgroup_id_x 1
.end_amdhsa_kernel
.text
```
